```python
import torch

def _softmax(x, axis=-1):
    return torch.softmax(x, dim=axis)
def _gelu(x):
    return torch.nn.functional.gelu(x, approximate="tanh")
def _silu(x):
    return torch.nn.functional.silu(x)
def _sigmoid(x):
    return torch.sigmoid(x)
def _layernorm(x, axis=-1, eps=1e-5):
    m = x.mean(dim=axis, keepdim=True)
    v = x.var(dim=axis, keepdim=True, unbiased=False)
    return (x - m) / torch.sqrt(v + eps)
def _scatter_add(tgt, idx, src, axis=0):
    return tgt.clone().index_add_(axis, idx, src)
def _segment_sum(src, seg, n):
    out = torch.zeros((n,) + src.shape[1:], dtype=src.dtype)
    return out.index_add_(0, seg, src)
def _pad(x, pw):
    flat = tuple(v for pair in reversed(pw) for v in pair)
    return torch.nn.functional.pad(x, flat)

kernel_name = 'sequential_preLN__linear_kernel_hedgehog__dense_activation_gelu__prompt'

def setup_inputs():

    _w = (lambda a: (lambda t: t.to(torch.bfloat16) if t.is_floating_point() else t)(torch.as_tensor(a)))
    def _A_setup():
        B, S, D, H = 1, 2048, 512, 32
        Dh = D // H
        return {
            "x": _w((lambda *s: torch.randn(*s, dtype=torch.bfloat16) * 0.05)(B, S, D)),
            "wqkv": _w((lambda *s: torch.randn(*s, dtype=torch.bfloat16) * 0.2)(D, 3 * D)),
            "w_phi": _w((lambda *s: torch.randn(*s, dtype=torch.bfloat16) * 0.2)(H, Dh, Dh) * (Dh ** -0.5)),
            "wo": _w((lambda *s: torch.randn(*s, dtype=torch.bfloat16) * 0.05)(D, D)),
        }
    _A_in = _A_setup()

    def _B_setup():
        B, S, D, F = 1, 2048, 512, 1792
        return {
            "x": _w((lambda *s: torch.randn(*s, dtype=torch.bfloat16) * 0.05)(B, S, D)),
            "w1": _w((lambda *s: torch.randn(*s, dtype=torch.bfloat16) * 3.2)(D, F) * (D ** -0.5)),
            "b1": _w((lambda *s: torch.randn(*s, dtype=torch.bfloat16) * 0.1)(F) * 0.01),
            "w2": _w((lambda *s: torch.randn(*s, dtype=torch.bfloat16) * 0.1)(F, D) * (F ** -0.5)),
            "b2": _w((lambda *s: torch.randn(*s, dtype=torch.bfloat16) * 0.1)(D) * 0.01),
        }
    _B_in = _B_setup()

    return {
        "A_x": _A_in["x"],
        "A_wqkv": _A_in["wqkv"],
        "A_w_phi": _A_in["w_phi"],
        "A_wo": _A_in["wo"],
        "B_x": _B_in["x"],
        "B_w1": _B_in["w1"],
        "B_b1": _B_in["b1"],
        "B_w2": _B_in["w2"],
        "B_b2": _B_in["b2"],
    }

def reference(A_x, A_wqkv, A_w_phi, A_wo, B_x, B_w1, B_b1, B_w2, B_b2):
    def _A_ref(x, wqkv, w_phi, wo):
        B, S, D = x.shape
        H = 32; Dh = D // H
        qkv = (lambda x, *d: x.permute(*d))((x @ wqkv).reshape(B, S, 3, H, Dh), 2, 0, 3, 1, 4)
        q, k, v = qkv[0], qkv[1], qkv[2]
        pq = torch.einsum("bhsd,hdf->bhsf", q, w_phi)
        pk = torch.einsum("bhsd,hdf->bhsf", k, w_phi)
        phi_q = torch.concatenate([_softmax(pq, axis=-1), _softmax(-pq, axis=-1)], axis=-1)
        phi_k = torch.concatenate([_softmax(pk, axis=-1), _softmax(-pk, axis=-1)], axis=-1)
        kv = torch.einsum("bhsf,bhsd->bhfd", phi_k, v)
        z  = torch.einsum("bhsf->bhf", phi_k)
        num = torch.einsum("bhqf,bhfd->bhqd", phi_q, kv)
        den = torch.einsum("bhqf,bhf->bhq", phi_q, z)[..., None] + 1e-6
        o = num / den
        return (lambda x, *d: x.permute(*d))(o, 0, 2, 1, 3).reshape(B, S, D) @ wo

    def _B_ref(x, w1, b1, w2, b2):
        h = torch.einsum("bsd,df->bsf", x, w1) + b1
        h = _gelu(h)
        return torch.einsum("bsf,fd->bsd", h, w2) + b2

    x = A_x
    h = x + _A_ref(_layernorm(x, axis=-1), A_wqkv, A_w_phi, A_wo)
    h2 = h + _B_ref(_layernorm(h, axis=-1), B_w1, B_b1, B_w2, B_b2)
    return h2
```

```asm
; @launch grid=(256,1,1) block=(256,1,1) lds=163840
.amdgcn_target "amdgcn-amd-amdhsa--gfx950"
.text
.globl sequential_preLN__linear_kernel_hedgehog__dense_activation_gelu__prompt_kernel
.p2align 8
.type sequential_preLN__linear_kernel_hedgehog__dense_activation_gelu__prompt_kernel,@function
sequential_preLN__linear_kernel_hedgehog__dense_activation_gelu__prompt_kernel:
    s_load_dwordx2 s[4:5], s[0:1], 0
    s_load_dwordx2 s[8:9], s[0:1], 8
    s_cmp_ge_u32 s2, 256
    s_cbranch_scc1 L_end
    s_getpc_b64 s[60:61]
L_pc:
    s_lshr_b32 s74, s2, 3
    s_lshl_b32 s74, s74, 10
    s_min_u32 s74, s74, L_end-L_pc-1020
    s_add_u32 s60, s60, s74
    s_addc_u32 s61, s61, 0
    v_lshlrev_b32 v12, 2, v0
    v_mov_b32 v13, s61
    v_add_co_u32 v12, vcc, s60, v12
    s_nop 1
    v_addc_co_u32 v13, vcc, 0, v13, vcc
    global_load_dword v103, v[12:13], off
    v_lshrrev_b32 v1, 6, v0
    v_and_b32 v0, 63, v0
    s_bfe_u32 s74, s2, 0x20001
    v_readfirstlane_b32 s48, v1
    s_lshr_b32 s75, s2, 6
    s_lshl2_add_u32 s50, s74, s75
    s_bfe_u32 s54, s2, 0x30003
    s_and_b32 s74, s2, 1
    s_lshl3_add_u32 s49, s74, s54
    v_lshrrev_b32 v12, 2, v0
    v_mul_u32_u24 v122, 3072, v12
    v_and_b32 v12, 3, v0
    v_lshl_add_u32 v122, v12, 4, v122
    v_lshl_add_u32 v122, s49, 6, v122
    s_mul_i32 s73, s48, 49152
    s_add_u32 s73, s73, 1024
    s_lshl1_add_u32 s74, s75, s49
    s_and_b32 s55, s74, 7
    s_and_b32 s74, s2, 6
    s_and_b32 s75, s2, 1
    s_lshl2_add_u32 s74, s75, s74
    s_lshr_b32 s75, s2, 3
    s_and_b32 s75, s75, 3
    s_add_u32 s74, s74, s75
    s_and_b32 s55, s74, 7
    v_add_u32 v120, s73, v122
    s_lshl_b32 s52, s48, 10
    s_add_u32 s52, s52, 98304
    s_mul_i32 s71, s55, 196608
    s_mov_b32 m0, s52
    s_mov_b32 s10, 1572864
    s_mov_b32 s11, 0x20000
    s_mov_b32 s6, 2097152
    s_mov_b32 s7, 0x20000
    v_lshrrev_b32 v12, 4, v0
    v_and_b32 v13, 7, v0
    v_xor_b32 v12, v12, v13
    v_lshrrev_b32 v13, 3, v0
    v_lshlrev_b32 v13, 10, v13
    v_lshl_add_u32 v116, v12, 4, v13
    s_lshl2_add_u32 s72, s50, s48
    v_add_u32 v121, 1024, v120
    v_lshl_add_u32 v116, s72, 15, v116
    s_mul_i32 s57, s48, 21504
    s_lshl_b32 s3, s55, 7
    v_xor_b32 v117, 64, v116
    v_add_u32 v117, 7168, v117
    v_add_u32 v118, 14336, v116
    v_add_u32 v119, 14336, v117
    s_waitcnt lgkmcnt(0)
    s_load_dwordx2 s[12:13], s[0:1], 16
    s_load_dwordx2 s[32:33], s[0:1], 88
    s_load_dwordx2 s[36:37], s[0:1], 80
    s_load_dwordx2 s[16:17], s[0:1], 24
    s_load_dwordx2 s[20:21], s[0:1], 40
    s_load_dwordx2 s[24:25], s[0:1], 56
    s_load_dwordx2 s[28:29], s[0:1], 72
    s_load_dwordx2 s[40:41], s[0:1], 48
    s_load_dwordx2 s[44:45], s[0:1], 64
    buffer_load_dwordx4 v120, s[8:11], s71 offen lds
    s_add_u32 m0, s52, 32768
    s_nop 0
    buffer_load_dwordx4 v121, s[8:11], s71 offen lds
    s_add_u32 m0, s52, 4096
    s_add_u32 s95, s55, 1
    s_and_b32 s95, s95, 7
    s_mul_i32 s71, s95, 196608
    buffer_load_dwordx4 v120, s[8:11], s71 offen lds
    s_add_u32 m0, s52, 36864
    s_nop 0
    buffer_load_dwordx4 v121, s[8:11], s71 offen lds
    s_add_u32 m0, s57, 0
    s_nop 0
    buffer_load_dwordx4 v116, s[4:7], s3 offen lds
    buffer_load_dwordx4 v117, s[4:7], s3 offen offset:1024 lds
    buffer_load_dwordx4 v118, s[4:7], s3 offen offset:2048 lds
    buffer_load_dwordx4 v119, s[4:7], s3 offen offset:3072 lds
    s_mov_b32 s14, 16384
    s_mov_b32 s15, 0x20000
    s_mov_b32 s18, 524288
    s_mov_b32 s19, 0x20000
    s_mov_b32 s22, 1835008
    s_mov_b32 s23, 0x20000
    s_mov_b32 s26, 1835008
    s_mov_b32 s27, 0x20000
    s_mov_b32 s30, 2097152
    s_mov_b32 s31, 0x20000
    s_mov_b32 s34, 22020096
    s_mov_b32 s35, 0x20000
    s_mov_b32 s38, 256
    s_mov_b32 s39, 0x20000
    s_mov_b32 s42, 3584
    s_mov_b32 s43, 0x20000
    s_mov_b32 s46, 1024
    s_mov_b32 s47, 0x20000
    s_and_b32 s72, s2, 7
    s_lshr_b32 s75, s2, 7
    s_lshl1_add_u32 s51, s72, s75
    s_bfe_u32 s53, s2, 0x10006
    s_bfe_u32 s101, s2, 0x40003
    s_or_b32 s58, s2, s48
    v_lshlrev_b32 v1, 4, v0
    s_lshl_b32 s72, s49, 10
    s_mov_b32 m0, 90112
    s_waitcnt lgkmcnt(0)
    s_cmp_lg_u32 s58, 0
    s_cbranch_scc1 L_noinit
    v_lshlrev_b32 v12, 8, v0
    v_mov_b32 v13, 0
    buffer_store_dword v13, v12, s[32:35], 0 offen sc1
    buffer_store_dword v13, v12, s[32:35], 0 offen offset:128 sc1
L_noinit:
    buffer_load_dwordx4 v1, s[12:15], s72 offen lds
    s_add_u32 m0, s52, 8192
    s_add_u32 s95, s55, 2
    s_and_b32 s95, s95, 7
    s_mul_i32 s71, s95, 196608
    buffer_load_dwordx4 v120, s[8:11], s71 offen lds
    s_add_u32 m0, s52, 40960
    s_nop 0
    buffer_load_dwordx4 v121, s[8:11], s71 offen lds
    s_mov_b32 s70, 0x3f803f80
    v_lshrrev_b32 v12, 5, v0
    v_lshlrev_b32 v12, 9, v12
    v_bfe_u32 v13, v0, 2, 2
    v_lshl_add_u32 v12, v13, 6, v12
    v_bfe_u32 v13, v0, 4, 1
    v_lshl_add_u32 v12, v13, 5, v12
    v_and_b32 v13, 3, v0
    v_lshl_add_u32 v5, v13, 3, v12
    v_and_b32 v12, 31, v0
    v_lshlrev_b32 v13, 7, v12
    v_add_u32 v13, s57, v13
    v_bfe_u32 v12, v0, 1, 3
    v_lshrrev_b32 v14, 5, v0
    v_xor_b32 v12, v12, v14
    v_mov_b32 v10, s48
    v_add_u32 v15, 0, v10
    v_and_b32 v15, 3, v15
    v_lshl_add_u32 v14, v15, 10, v5
    v_add_u32 v112, 98304, v14
    v_add_u32 v14, 12288, v14
    v_accvgpr_write_b32 a240, v14
    v_lshlrev_b32 v15, 1, v15
    v_xor_b32 v14, v15, v12
    v_lshl_add_u32 v6, v14, 4, v13
    v_add_u32 v15, 1, v10
    v_and_b32 v15, 3, v15
    v_lshl_add_u32 v14, v15, 10, v5
    v_add_u32 v113, 98304, v14
    v_add_u32 v14, 12288, v14
    v_accvgpr_write_b32 a241, v14
    v_lshlrev_b32 v15, 1, v15
    v_xor_b32 v14, v15, v12
    v_lshl_add_u32 v7, v14, 4, v13
    v_add_u32 v15, 2, v10
    v_and_b32 v15, 3, v15
    v_lshl_add_u32 v14, v15, 10, v5
    v_add_u32 v114, 98304, v14
    v_add_u32 v14, 12288, v14
    v_accvgpr_write_b32 a242, v14
    v_lshlrev_b32 v15, 1, v15
    v_xor_b32 v14, v15, v12
    v_lshl_add_u32 v8, v14, 4, v13
    v_add_u32 v15, 3, v10
    v_and_b32 v15, 3, v15
    v_lshl_add_u32 v14, v15, 10, v5
    v_add_u32 v115, 98304, v14
    v_add_u32 v14, 12288, v14
    v_accvgpr_write_b32 a243, v14
    v_lshlrev_b32 v15, 1, v15
    v_xor_b32 v14, v15, v12
    v_lshl_add_u32 v9, v14, 4, v13
    v_mov_b32 v96, 0
    v_mov_b32 v97, 0
    v_mov_b32 v98, 0
    v_mov_b32 v99, 0
    v_mov_b32 v100, 0
    v_mov_b32 v101, 0
    v_mov_b32 v102, 0
    v_lshrrev_b32 v13, 5, v0
    v_lshlrev_b32 v13, 7, v13
    v_bfe_u32 v14, v0, 2, 2
    v_lshl_add_u32 v13, v14, 5, v13
    v_bfe_u32 v14, v0, 4, 1
    v_lshl_add_u32 v13, v14, 4, v13
    v_bfe_u32 v14, v0, 1, 1
    v_lshl_add_u32 v13, v14, 3, v13
    v_add_u32 v123, 90112, v13
    v_bfe_u32 v14, v0, 2, 1
    v_mul_u32_u24 v14, 0x8000, v14
    v_lshl_or_b32 v124, v14, 16, v14
    v_lshrrev_b32 v15, 4, v0
    v_lshlrev_b32 v15, 1, v15
    v_and_b32 v11, 7, v0
    v_xor_b32 v15, v15, v11
    v_lshrrev_b32 v11, 3, v0
    v_lshlrev_b32 v11, 10, v11
    v_lshl_add_u32 v11, v15, 4, v11
    v_and_b32 v13, 31, v0
    v_lshlrev_b32 v13, 5, v13
    v_add_u32 v13, s57, v13
    v_lshrrev_b32 v15, 5, v0
    v_lshl_add_u32 v3, v15, 10, v13
    v_lshl_add_u32 v2, v15, 4, v13
    v_lshrrev_b32 v13, 2, v0
    v_lshlrev_b32 v13, 5, v13
    v_and_b32 v14, 3, v0
    v_lshl_add_u32 v13, v14, 3, v13
    v_lshl_add_u32 v4, v10, 10, v13
    v_lshrrev_b32 v14, 1, v10
    v_lshl_add_u32 v5, v14, 10, v13
    v_add_u32 v5, 4096, v5
    v_add_u32 v13, 94720, v1
    v_lshl_add_u32 v12, v10, 2, v13
    v_lshlrev_b32 v14, 2, v0
    v_add_u32 v14, 94208, v14
    v_lshlrev_b32 v10, 4, v15
    v_add_u32 v10, 94208, v10
    s_mul_i32 s72, s49, 224
    v_add_u32 v15, 0, v0
    v_mul_u32_u24 v125, 4682, v15
    v_lshrrev_b32 v125, 16, v125
    v_mul_u32_u24 v125, 3360, v125
    v_lshl_add_u32 v125, v15, 4, v125
    v_add_u32 v125, s72, v125
    v_accvgpr_write_b32 a244, v125
    v_add_u32 v15, 64, v0
    v_mul_u32_u24 v125, 4682, v15
    v_lshrrev_b32 v125, 16, v125
    v_mul_u32_u24 v125, 3360, v125
    v_lshl_add_u32 v125, v15, 4, v125
    v_add_u32 v125, s72, v125
    v_subrev_u32 v125, 1024, v125
    v_accvgpr_write_b32 a245, v125
    v_add_u32 v15, 128, v0
    v_mul_u32_u24 v125, 4682, v15
    v_lshrrev_b32 v125, 16, v125
    v_mul_u32_u24 v125, 3360, v125
    v_lshl_add_u32 v125, v15, 4, v125
    v_add_u32 v125, s72, v125
    v_subrev_u32 v125, 2048, v125
    v_accvgpr_write_b32 a246, v125
    v_add_u32 v15, 192, v0
    v_mul_u32_u24 v125, 4682, v15
    v_lshrrev_b32 v125, 16, v125
    v_mul_u32_u24 v125, 3360, v125
    v_lshl_add_u32 v125, v15, 4, v125
    v_add_u32 v125, s72, v125
    v_subrev_u32 v125, 3072, v125
    v_accvgpr_write_b32 a247, v125
    v_add_u32 v15, 256, v0
    v_mul_u32_u24 v125, 4682, v15
    v_lshrrev_b32 v125, 16, v125
    v_mul_u32_u24 v125, 3360, v125
    v_lshl_add_u32 v125, v15, 4, v125
    v_add_u32 v125, s72, v125
    v_accvgpr_write_b32 a248, v125
    v_add_u32 v15, 320, v0
    v_mul_u32_u24 v125, 4682, v15
    v_lshrrev_b32 v125, 16, v125
    v_mul_u32_u24 v125, 3360, v125
    v_lshl_add_u32 v125, v15, 4, v125
    v_add_u32 v125, s72, v125
    v_subrev_u32 v125, 1024, v125
    v_accvgpr_write_b32 a249, v125
    v_add_u32 v15, 384, v0
    v_mul_u32_u24 v125, 4682, v15
    v_lshrrev_b32 v125, 16, v125
    v_mul_u32_u24 v125, 3360, v125
    v_lshl_add_u32 v125, v15, 4, v125
    v_add_u32 v125, s72, v125
    v_subrev_u32 v125, 2048, v125
    v_accvgpr_write_b32 a250, v125
    v_lshrrev_b32 v15, 2, v0
    v_lshlrev_b32 v125, 7, v15
    v_and_b32 v15, 6, v15
    v_bfe_u32 v126, v0, 1, 1
    v_lshl_add_u32 v125, v126, 4, v125
    v_and_b32 v126, 1, v0
    v_lshl_add_u32 v125, v126, 3, v125
    v_add_u32 v125, s57, v125
    v_add_u32 v125, 8192, v125
    v_xor_b32 v126, 0, v15
    v_lshl_add_u32 v126, v126, 4, v125
    v_accvgpr_write_b32 a251, v126
    v_xor_b32 v126, 2, v15
    v_lshl_add_u32 v126, v126, 4, v125
    v_accvgpr_write_b32 a252, v126
    v_xor_b32 v126, 4, v15
    v_lshl_add_u32 v126, v126, 4, v125
    v_accvgpr_write_b32 a253, v126
    v_xor_b32 v126, 6, v15
    v_lshl_add_u32 v126, v126, 4, v125
    v_accvgpr_write_b32 a254, v126
    s_mov_b32 s62, 4096
    s_mov_b32 s63, 8192
    s_mov_b32 s64, 12288
    s_mov_b32 s65, 16384
    s_mov_b32 s66, 20480
    s_mov_b32 s67, 24576
    s_mov_b32 s68, 28672
    s_mov_b32 s69, 32768
    s_mov_b32 s96, 36864
    s_mov_b32 s97, 40960
    s_mov_b32 s98, 45056
    s_mov_b32 s99, 49152
    s_mov_b32 s100, 53248
    s_lshl_b32 s74, s48, 13
    s_lshl_b32 s75, s54, 7
    s_add_u32 s56, s74, s75
    s_lshl_b32 s72, s2, 1
    s_add_u32 s72, s72, s48
    s_and_b32 s15, s72, 7
    s_lshl_b32 s75, s15, 7
    s_lshr_b32 s61, s72, 3
    s_cmp_ge_u32 s48, 2
    s_cselect_b32 s61, 56, s61
    s_mul_i32 s73, s61, 37
    s_lshr_b32 s73, s73, 8
    s_mul_i32 s74, s73, 7
    s_sub_u32 s72, s61, s74
    s_mul_i32 s73, s73, 224
    s_lshl_b32 s74, s72, 5
    s_add_u32 s73, s73, s74
    s_cmp_ge_u32 s72, 4
    s_cselect_b32 s74, 16, 0
    s_sub_u32 s73, s73, s74
    s_cmp_eq_u32 s72, 3
    s_cselect_b32 s74, 112, 16
    s_add_u32 s74, s74, s73
    s_lshl_b32 s73, s73, 10
    s_add_u32 s59, s73, s75
    s_lshl_b32 s74, s74, 10
    s_add_u32 s60, s74, s75
    v_lshrrev_b32 v86, 5, v0
    v_lshlrev_b32 v86, 4, v86
    v_bfe_u32 v87, v0, 2, 3
    v_add_u32 v86, v86, v87
    v_lshlrev_b32 v86, 7, v86
    v_and_b32 v87, 6, v87
    v_bfe_u32 v88, v0, 1, 1
    v_lshl_add_u32 v86, v88, 4, v86
    v_and_b32 v88, 1, v0
    v_lshl_add_u32 v86, v88, 3, v86
    v_add_u32 v86, 98304, v86
    v_xor_b32 v88, 0, v87
    v_lshl_add_u32 v90, v88, 4, v86
    v_xor_b32 v88, 2, v87
    v_lshl_add_u32 v91, v88, 4, v86
    v_xor_b32 v88, 4, v87
    v_lshl_add_u32 v92, v88, 4, v86
    v_xor_b32 v88, 6, v87
    v_lshl_add_u32 v93, v88, 4, v86
    s_lshr_b32 s72, s48, 1
    s_mul_i32 s72, s72, 1088
    s_and_b32 s73, s48, 1
    s_lshl_b32 s73, s73, 5
    s_add_u32 s72, s72, s73
    s_add_u32 s72, s72, 86016
    v_and_b32 v84, 1, v0
    v_lshrrev_b32 v85, 5, v0
    v_lshl_add_u32 v84, v84, 1, v85
    v_bfe_u32 v85, v0, 1, 1
    v_lshl_add_u32 v84, v85, 3, v84
    v_bfe_u32 v85, v0, 2, 1
    v_lshl_add_u32 v84, v85, 2, v84
    v_lshlrev_b32 v84, 6, v84
    v_bfe_u32 v85, v0, 3, 2
    v_lshl_add_u32 v84, v85, 3, v84
    v_add_u32 v84, s72, v84
    v_and_b32 v89, 15, v0
    v_lshlrev_b32 v85, 1, v89
    v_add_u32 v85, s72, v85
    v_and_b32 v86, 31, v0
    v_min_u32 v86, 16, v86
    v_lshlrev_b32 v86, 6, v86
    v_lshrrev_b32 v88, 5, v0
    v_lshl_add_u32 v86, v88, 5, v86
    v_add_u32 v86, 86016, v86
    s_and_b32 s72, s50, 3
    s_lshl2_add_u32 s72, s72, s48
    s_lshl_b32 s72, s72, 5
    s_add_u32 s72, s72, s49
    s_lshl_b32 s72, s72, 10
    s_lshr_b32 s73, s50, 2
    s_lshl_b32 s73, s73, 21
    s_add_u32 s72, s72, s73
    s_add_u32 s72, s72, 4194304
    v_bfe_u32 v87, v0, 4, 1
    v_mul_u32_u24 v87, 16384, v87
    v_lshl_add_u32 v87, v89, 4, v87
    v_lshl_add_u32 v87, v88, 8, v87
    v_add_u32 v87, s72, v87
    s_lshl_b32 s72, s49, 2
    s_add_u32 s72, s72, s48
    s_lshl_b32 s73, s72, 13
    s_add_u32 s73, s73, 524288
    v_add_u32 v80, s73, v1
    s_lshl_b32 s73, s72, 11
    s_add_u32 s73, s73, 1048576
    v_lshrrev_b32 v82, 4, v0
    v_lshlrev_b32 v82, 5, v82
    v_add_u32 v82, v82, v89
    v_lshlrev_b32 v82, 2, v82
    v_add_u32 v82, s73, v82
    s_lshl_b32 s72, s54, 2
    s_add_u32 s72, s72, s48
    s_mul_i32 s72, s72, 57344
    s_add_u32 s72, s72, 2097152
    v_add_u32 v83, s72, v1
    v_accvgpr_write_b32 a48, v90
    v_accvgpr_write_b32 a49, v91
    v_accvgpr_write_b32 a50, v92
    v_accvgpr_write_b32 a51, v93
    v_accvgpr_write_b32 a64, v84
    v_accvgpr_write_b32 a65, v85
    v_accvgpr_write_b32 a66, v86
    v_accvgpr_write_b32 a67, v87
    v_accvgpr_write_b32 a80, v80
    v_accvgpr_write_b32 a81, v82
    v_accvgpr_write_b32 a82, v83
    s_add_u32 m0, s52, 12288
    s_add_u32 s95, s55, 3
    s_and_b32 s95, s95, 7
    s_mul_i32 s71, s95, 196608
    buffer_load_dwordx4 v120, s[8:11], s71 offen lds
    s_add_u32 m0, s52, 45056
    s_nop 0
    buffer_load_dwordx4 v121, s[8:11], s71 offen lds
    s_add_u32 m0, s57, 4096
    s_add_u32 s3, s3, 128
    s_and_b32 s3, s3, 0x3ff
    buffer_load_dwordx4 v116, s[4:7], s3 offen lds
    buffer_load_dwordx4 v117, s[4:7], s3 offen offset:1024 lds
    buffer_load_dwordx4 v118, s[4:7], s3 offen offset:2048 lds
    buffer_load_dwordx4 v119, s[4:7], s3 offen offset:3072 lds
    s_add_u32 m0, s52, 16384
    s_add_u32 s95, s55, 4
    s_and_b32 s95, s95, 7
    s_mul_i32 s71, s95, 196608
    buffer_load_dwordx4 v120, s[8:11], s71 offen lds
    s_add_u32 m0, s52, 49152
    s_nop 0
    buffer_load_dwordx4 v121, s[8:11], s71 offen lds
    s_add_u32 m0, s57, 8192
    s_add_u32 s3, s3, 128
    s_and_b32 s3, s3, 0x3ff
    buffer_load_dwordx4 v116, s[4:7], s3 offen lds
    buffer_load_dwordx4 v117, s[4:7], s3 offen offset:1024 lds
    s_waitcnt vmcnt(12)
    s_cmp_lg_u32 s58, 0
    s_cbranch_scc1 L_noinit2
    v_mov_b32 v15, 1
    s_mov_b64 exec, 1
    buffer_store_dword v15, off, s[36:39], 0 sc1
    s_mov_b64 exec, -1
L_noinit2:
    s_barrier
    ds_read_b128 v[128:131], v6
    ds_read_b128 v[132:135], v7
    ds_read_b128 v[136:139], v8
    ds_read_b128 v[140:143], v9
    ds_read_b64_tr_b16 v[64:65], v112
    ds_read_b64_tr_b16 v[66:67], v112 offset:256
    ds_read_b64_tr_b16 v[68:69], v112 offset:32768
    ds_read_b64_tr_b16 v[70:71], v112 offset:33024
    ds_read_b64_tr_b16 a[0:1], v113
    ds_read_b64_tr_b16 a[2:3], v113 offset:256
    ds_read_b64_tr_b16 a[4:5], v113 offset:32768
    ds_read_b64_tr_b16 a[6:7], v113 offset:33024
    ds_read_b64_tr_b16 a[8:9], v114
    ds_read_b64_tr_b16 a[10:11], v114 offset:256
    ds_read_b64_tr_b16 a[12:13], v114 offset:32768
    ds_read_b64_tr_b16 a[14:15], v114 offset:33024
    ds_read_b64_tr_b16 a[16:17], v115
    ds_read_b64_tr_b16 a[18:19], v115 offset:256
    ds_read_b64_tr_b16 a[20:21], v115 offset:32768
    ds_read_b64_tr_b16 a[22:23], v115 offset:33024
    ds_read_b64_tr_b16 v[104:105], v123
    ds_read_b64_tr_b16 v[106:107], v123 offset:256
    ds_read_b64_tr_b16 v[108:109], v123 offset:512
    ds_read_b64_tr_b16 v[110:111], v123 offset:768
    s_waitcnt lgkmcnt(4)
    v_dot2c_f32_bf16 v100, s70, v64
    v_dot2c_f32_bf16 v101, s70, v68
    v_dot2c_f32_bf16 v100, s70, v65
    v_dot2c_f32_bf16 v101, s70, v69
    v_dot2c_f32_bf16 v100, s70, v66
    v_dot2c_f32_bf16 v101, s70, v70
    v_dot2c_f32_bf16 v100, s70, v67
    v_dot2c_f32_bf16 v101, s70, v71
    v_mfma_f32_32x32x16_bf16 v[16:31], v[64:67], v[128:131], 0
    ds_read_b64_tr_b16 v[72:73], v112 offset:4096
    ds_read_b64_tr_b16 v[74:75], v112 offset:4352
    buffer_load_dwordx4 v118, s[4:7], s3 offen offset:2048 lds
    v_mfma_f32_32x32x16_bf16 v[32:47], v[68:71], v[128:131], 0
    ds_read_b64_tr_b16 v[76:77], v112 offset:36864
    ds_read_b64_tr_b16 v[78:79], v112 offset:37120
    buffer_load_dwordx4 v119, s[4:7], s3 offen offset:3072 lds
    v_mfma_f32_32x32x16_bf16 v[16:31], a[0:3], v[132:135], v[16:31]
    ds_read_b64_tr_b16 a[24:25], v113 offset:4096
    ds_read_b64_tr_b16 a[26:27], v113 offset:4352
    s_add_u32 m0, s52, 20480
    s_add_u32 s95, s55, 5
    s_and_b32 s95, s95, 7
    s_mul_i32 s71, s95, 196608
    buffer_load_dwordx4 v120, s[8:11], s71 offen lds
    s_add_u32 m0, s52, 53248
    v_mfma_f32_32x32x16_bf16 v[32:47], a[4:7], v[132:135], v[32:47]
    s_waitcnt vmcnt(7)
    ds_read_b64_tr_b16 a[28:29], v113 offset:36864
    ds_read_b64_tr_b16 a[30:31], v113 offset:37120
    ds_read_b128 v[144:147], v6 offset:4096
    v_mfma_f32_32x32x16_bf16 v[16:31], a[8:11], v[136:139], v[16:31]
    ds_read_b64_tr_b16 a[32:33], v114 offset:4096
    ds_read_b64_tr_b16 a[34:35], v114 offset:4352
    ds_read_b128 v[148:151], v7 offset:4096
    v_mfma_f32_32x32x16_bf16 v[32:47], a[12:15], v[136:139], v[32:47]
    ds_read_b64_tr_b16 a[36:37], v114 offset:36864
    ds_read_b64_tr_b16 a[38:39], v114 offset:37120
    ds_read_b128 v[152:155], v8 offset:4096
    v_mfma_f32_32x32x16_bf16 v[16:31], a[16:19], v[140:143], v[16:31]
    ds_read_b64_tr_b16 a[40:41], v115 offset:4096
    ds_read_b64_tr_b16 a[42:43], v115 offset:4352
    ds_read_b128 v[156:159], v9 offset:4096
    v_mfma_f32_32x32x16_bf16 v[32:47], a[20:23], v[140:143], v[32:47]
    ds_read_b64_tr_b16 a[44:45], v115 offset:36864
    ds_read_b64_tr_b16 a[46:47], v115 offset:37120
    buffer_load_dwordx4 v121, s[8:11], s71 offen lds
    v_dot2c_f32_bf16 v96, s70, v128
    v_dot2c_f32_bf16 v98, v128, v128
    v_dot2c_f32_bf16 v97, s70, v129
    v_dot2c_f32_bf16 v99, v129, v129
    v_dot2c_f32_bf16 v96, s70, v130
    v_dot2c_f32_bf16 v98, v130, v130
    v_dot2c_f32_bf16 v97, s70, v131
    s_add_u32 m0, s57, 12288
    s_add_u32 s3, s3, 128
    s_and_b32 s3, s3, 0x3ff
    buffer_load_dwordx4 v116, s[4:7], s3 offen lds
    v_dot2c_f32_bf16 v99, v131, v131
    v_dot2c_f32_bf16 v96, s70, v132
    v_dot2c_f32_bf16 v98, v132, v132
    v_dot2c_f32_bf16 v97, s70, v133
    v_dot2c_f32_bf16 v99, v133, v133
    v_dot2c_f32_bf16 v96, s70, v134
    v_dot2c_f32_bf16 v98, v134, v134
    v_dot2c_f32_bf16 v97, s70, v135
    v_dot2c_f32_bf16 v99, v135, v135
    buffer_load_dwordx4 v117, s[4:7], s3 offen offset:1024 lds
    v_dot2c_f32_bf16 v96, s70, v136
    v_dot2c_f32_bf16 v98, v136, v136
    v_dot2c_f32_bf16 v97, s70, v137
    v_dot2c_f32_bf16 v99, v137, v137
    v_dot2c_f32_bf16 v96, s70, v138
    v_dot2c_f32_bf16 v98, v138, v138
    v_dot2c_f32_bf16 v97, s70, v139
    v_dot2c_f32_bf16 v99, v139, v139
    v_dot2c_f32_bf16 v96, s70, v140
    v_dot2c_f32_bf16 v98, v140, v140
    v_dot2c_f32_bf16 v97, s70, v141
    v_dot2c_f32_bf16 v99, v141, v141
    buffer_load_dwordx4 v118, s[4:7], s3 offen offset:2048 lds
    v_dot2c_f32_bf16 v96, s70, v142
    v_dot2c_f32_bf16 v98, v142, v142
    v_dot2c_f32_bf16 v97, s70, v143
    v_dot2c_f32_bf16 v99, v143, v143
    s_waitcnt lgkmcnt(0)
    v_dot2c_f32_bf16 v100, s70, v72
    v_dot2c_f32_bf16 v101, s70, v76
    v_dot2c_f32_bf16 v100, s70, v73
    v_dot2c_f32_bf16 v101, s70, v77
    v_dot2c_f32_bf16 v100, s70, v74
    v_dot2c_f32_bf16 v101, s70, v78
    v_dot2c_f32_bf16 v100, s70, v75
    v_dot2c_f32_bf16 v101, s70, v79
    v_mfma_f32_32x32x16_bf16 v[16:31], v[72:75], v[144:147], v[16:31]
    buffer_load_dwordx4 v119, s[4:7], s3 offen offset:3072 lds
    v_mfma_f32_32x32x16_bf16 v[32:47], v[76:79], v[144:147], v[32:47]
    s_waitcnt vmcnt(6)
    s_barrier
    ds_read_b64_tr_b16 v[64:65], v112 offset:8192
    ds_read_b64_tr_b16 v[66:67], v112 offset:8448
    ds_read_b64_tr_b16 v[68:69], v112 offset:40960
    ds_read_b64_tr_b16 v[70:71], v112 offset:41216
    ds_read_b128 v[160:163], v6 offset:8192
    ds_read_b128 v[164:167], v7 offset:8192
    v_mfma_f32_32x32x16_bf16 v[16:31], a[24:27], v[148:151], v[16:31]
    ds_read_b64_tr_b16 a[0:1], v113 offset:8192
    ds_read_b64_tr_b16 a[2:3], v113 offset:8448
    ds_read_b128 v[168:171], v8 offset:8192
    v_mfma_f32_32x32x16_bf16 v[32:47], a[28:31], v[148:151], v[32:47]
    ds_read_b64_tr_b16 a[4:5], v113 offset:40960
    ds_read_b64_tr_b16 a[6:7], v113 offset:41216
    ds_read_b128 v[172:175], v9 offset:8192
    v_mfma_f32_32x32x16_bf16 v[16:31], a[32:35], v[152:155], v[16:31]
    ds_read_b64_tr_b16 a[8:9], v114 offset:8192
    ds_read_b64_tr_b16 a[10:11], v114 offset:8448
    s_add_u32 m0, s52, 24576
    s_add_u32 s95, s55, 6
    s_and_b32 s95, s95, 7
    s_mul_i32 s71, s95, 196608
    buffer_load_dwordx4 v120, s[8:11], s71 offen lds
    s_add_u32 m0, s52, 57344
    v_mfma_f32_32x32x16_bf16 v[32:47], a[36:39], v[152:155], v[32:47]
    ds_read_b64_tr_b16 a[12:13], v114 offset:40960
    ds_read_b64_tr_b16 a[14:15], v114 offset:41216
    buffer_load_dwordx4 v121, s[8:11], s71 offen lds
    v_mfma_f32_32x32x16_bf16 v[16:31], a[40:43], v[156:159], v[16:31]
    ds_read_b64_tr_b16 a[16:17], v115 offset:8192
    ds_read_b64_tr_b16 a[18:19], v115 offset:8448
    v_mfma_f32_32x32x16_bf16 v[32:47], a[44:47], v[156:159], v[32:47]
    ds_read_b64_tr_b16 a[20:21], v115 offset:40960
    ds_read_b64_tr_b16 a[22:23], v115 offset:41216
    s_add_u32 m0, s57, 16384
    s_add_u32 s3, s3, 128
    s_and_b32 s3, s3, 0x3ff
    buffer_load_dwordx4 v116, s[4:7], s3 offen lds
    v_xor_b32 v104, v104, v124
    v_xor_b32 v105, v105, v124
    v_xor_b32 v106, v106, v124
    v_xor_b32 v107, v107, v124
    v_xor_b32 v108, v108, v124
    v_xor_b32 v109, v109, v124
    v_xor_b32 v110, v110, v124
    v_xor_b32 v111, v111, v124
    v_dot2c_f32_bf16 v96, s70, v144
    buffer_load_dwordx4 v117, s[4:7], s3 offen offset:1024 lds
    v_dot2c_f32_bf16 v98, v144, v144
    v_dot2c_f32_bf16 v97, s70, v145
    v_dot2c_f32_bf16 v99, v145, v145
    v_dot2c_f32_bf16 v96, s70, v146
    v_dot2c_f32_bf16 v98, v146, v146
    v_dot2c_f32_bf16 v97, s70, v147
    v_dot2c_f32_bf16 v99, v147, v147
    v_dot2c_f32_bf16 v96, s70, v148
    v_dot2c_f32_bf16 v98, v148, v148
    v_dot2c_f32_bf16 v97, s70, v149
    v_dot2c_f32_bf16 v99, v149, v149
    buffer_load_dwordx4 v118, s[4:7], s3 offen offset:2048 lds
    v_dot2c_f32_bf16 v96, s70, v150
    v_dot2c_f32_bf16 v98, v150, v150
    v_dot2c_f32_bf16 v97, s70, v151
    v_dot2c_f32_bf16 v99, v151, v151
    v_dot2c_f32_bf16 v96, s70, v152
    v_dot2c_f32_bf16 v98, v152, v152
    v_dot2c_f32_bf16 v97, s70, v153
    v_dot2c_f32_bf16 v99, v153, v153
    v_dot2c_f32_bf16 v96, s70, v154
    v_dot2c_f32_bf16 v98, v154, v154
    v_dot2c_f32_bf16 v97, s70, v155
    v_dot2c_f32_bf16 v99, v155, v155
    buffer_load_dwordx4 v119, s[4:7], s3 offen offset:3072 lds
    v_dot2c_f32_bf16 v96, s70, v156
    v_dot2c_f32_bf16 v98, v156, v156
    v_dot2c_f32_bf16 v97, s70, v157
    v_dot2c_f32_bf16 v99, v157, v157
    v_dot2c_f32_bf16 v96, s70, v158
    v_dot2c_f32_bf16 v98, v158, v158
    v_dot2c_f32_bf16 v97, s70, v159
    v_dot2c_f32_bf16 v99, v159, v159
    s_waitcnt lgkmcnt(0)
    v_dot2c_f32_bf16 v100, s70, v64
    v_dot2c_f32_bf16 v101, s70, v68
    v_dot2c_f32_bf16 v100, s70, v65
    v_dot2c_f32_bf16 v101, s70, v69
    v_dot2c_f32_bf16 v100, s70, v66
    v_dot2c_f32_bf16 v101, s70, v70
    v_dot2c_f32_bf16 v100, s70, v67
    v_dot2c_f32_bf16 v101, s70, v71
    v_mfma_f32_32x32x16_bf16 v[16:31], v[64:67], v[160:163], v[16:31]
    ds_read_b64_tr_b16 v[72:73], v112 offset:12288
    ds_read_b64_tr_b16 v[74:75], v112 offset:12544
    s_mov_b32 m0, 91136
    v_lshlrev_b32 v15, 2, v0
    s_mul_i32 s95, s49, 224
    buffer_load_dword v15, s[40:43], s95 offen lds
    s_mov_b32 m0, 91392
    s_lshl_b32 s95, s54, 7
    buffer_load_dword v15, s[44:47], s95 offen lds
    v_mfma_f32_32x32x16_bf16 v[32:47], v[68:71], v[160:163], v[32:47]
    ds_read_b64_tr_b16 v[76:77], v112 offset:45056
    ds_read_b64_tr_b16 v[78:79], v112 offset:45312
    s_lshl_b32 s95, s2, 2
    s_add_u32 s95, s95, s48
    s_mul_i32 s95, s95, 1792
    v_mul_u32_u24 v15, 28, v0
    buffer_load_dword v103, v15, s[20:23], s95 offen
    s_lshr_b32 s71, s50, 2
    s_lshl_b32 s71, s71, 21
    v_mov_b32 v15, 0x8000
    s_mov_b32 s95, 4128768
    v_writelane_b32 v15, s95, 1
    s_add_u32 s95, s71, 5767168
    v_writelane_b32 v15, s95, 2
    s_add_u32 s95, s71, 14675968
    v_writelane_b32 v15, s95, 3
    buffer_load_dword v103, v15, s[32:35], 0 offen
    buffer_load_dword v103, off, s[28:31], 0
    buffer_load_dword v103, off, s[36:39], 0 offset:128
    s_lshl_b32 s95, s2, 2
    s_add_u32 s95, s95, s48
    s_lshl_b32 s95, s95, 9
    v_lshlrev_b32 v15, 3, v0
    buffer_load_dword v103, v15, s[16:19], s95 offen
    s_lshr_b32 s71, s95, 10
    s_mul_i32 s71, s71, 2048
    s_add_u32 s95, s95, s71
    buffer_load_dword v103, v15, s[8:11], s95 offen
    v_mfma_f32_32x32x16_bf16 v[16:31], a[0:3], v[164:167], v[16:31]
    ds_read_b64_tr_b16 a[24:25], v113 offset:12288
    ds_read_b64_tr_b16 a[26:27], v113 offset:12544
    s_add_u32 m0, s52, 28672
    s_add_u32 s95, s55, 7
    s_and_b32 s95, s95, 7
    s_mul_i32 s71, s95, 196608
    buffer_load_dwordx4 v120, s[8:11], s71 offen lds
    s_add_u32 m0, s52, 61440
    v_mfma_f32_32x32x16_bf16 v[32:47], a[4:7], v[164:167], v[32:47]
    s_waitcnt vmcnt(15)
    ds_read_b64_tr_b16 a[28:29], v113 offset:45056
    ds_read_b64_tr_b16 a[30:31], v113 offset:45312
    ds_read_b128 v[176:179], v6 offset:12288
    v_mfma_f32_32x32x16_bf16 v[16:31], a[8:11], v[168:171], v[16:31]
    ds_read_b64_tr_b16 a[32:33], v114 offset:12288
    ds_read_b64_tr_b16 a[34:35], v114 offset:12544
    ds_read_b128 v[180:183], v7 offset:12288
    v_mfma_f32_32x32x16_bf16 v[32:47], a[12:15], v[168:171], v[32:47]
    ds_read_b64_tr_b16 a[36:37], v114 offset:45056
    ds_read_b64_tr_b16 a[38:39], v114 offset:45312
    ds_read_b128 v[184:187], v8 offset:12288
    v_mfma_f32_32x32x16_bf16 v[16:31], a[16:19], v[172:175], v[16:31]
    ds_read_b64_tr_b16 a[40:41], v115 offset:12288
    ds_read_b64_tr_b16 a[42:43], v115 offset:12544
    ds_read_b128 v[188:191], v9 offset:12288
    v_mfma_f32_32x32x16_bf16 v[32:47], a[20:23], v[172:175], v[32:47]
    ds_read_b64_tr_b16 a[44:45], v115 offset:45056
    ds_read_b64_tr_b16 a[46:47], v115 offset:45312
    buffer_load_dwordx4 v121, s[8:11], s71 offen lds
    v_dot2c_f32_bf16 v96, s70, v160
    s_add_u32 m0, s57, 0
    s_add_u32 s3, s3, 128
    s_and_b32 s3, s3, 0x3ff
    buffer_load_dwordx4 v116, s[4:7], s3 offen lds
    v_dot2c_f32_bf16 v98, v160, v160
    buffer_load_dwordx4 v117, s[4:7], s3 offen offset:1024 lds
    v_dot2c_f32_bf16 v97, s70, v161
    v_dot2c_f32_bf16 v99, v161, v161
    v_dot2c_f32_bf16 v96, s70, v162
    v_dot2c_f32_bf16 v98, v162, v162
    v_dot2c_f32_bf16 v97, s70, v163
    v_dot2c_f32_bf16 v99, v163, v163
    buffer_load_dwordx4 v118, s[4:7], s3 offen offset:2048 lds
    v_dot2c_f32_bf16 v96, s70, v164
    v_dot2c_f32_bf16 v98, v164, v164
    v_dot2c_f32_bf16 v97, s70, v165
    v_dot2c_f32_bf16 v99, v165, v165
    v_dot2c_f32_bf16 v96, s70, v166
    v_dot2c_f32_bf16 v98, v166, v166
    v_dot2c_f32_bf16 v97, s70, v167
    v_dot2c_f32_bf16 v99, v167, v167
    v_dot2c_f32_bf16 v96, s70, v168
    v_dot2c_f32_bf16 v98, v168, v168
    v_dot2c_f32_bf16 v97, s70, v169
    v_dot2c_f32_bf16 v99, v169, v169
    buffer_load_dwordx4 v119, s[4:7], s3 offen offset:3072 lds
    v_dot2c_f32_bf16 v96, s70, v170
    v_dot2c_f32_bf16 v98, v170, v170
    v_dot2c_f32_bf16 v97, s70, v171
    v_dot2c_f32_bf16 v99, v171, v171
    v_dot2c_f32_bf16 v96, s70, v172
    v_dot2c_f32_bf16 v98, v172, v172
    v_dot2c_f32_bf16 v97, s70, v173
    v_dot2c_f32_bf16 v99, v173, v173
    v_dot2c_f32_bf16 v96, s70, v174
    v_dot2c_f32_bf16 v98, v174, v174
    v_dot2c_f32_bf16 v97, s70, v175
    v_dot2c_f32_bf16 v99, v175, v175
    s_add_u32 m0, s57, 4096
    s_add_u32 s3, s3, 128
    s_and_b32 s3, s3, 0x3ff
    buffer_load_dwordx4 v116, s[4:7], s3 offen lds
    s_waitcnt lgkmcnt(0)
    v_dot2c_f32_bf16 v100, s70, v72
    v_dot2c_f32_bf16 v101, s70, v76
    v_dot2c_f32_bf16 v100, s70, v73
    v_dot2c_f32_bf16 v101, s70, v77
    v_dot2c_f32_bf16 v100, s70, v74
    v_dot2c_f32_bf16 v101, s70, v78
    v_dot2c_f32_bf16 v100, s70, v75
    v_dot2c_f32_bf16 v101, s70, v79
    v_mfma_f32_32x32x16_bf16 v[16:31], v[72:75], v[176:179], v[16:31]
    ds_read_b64_tr_b16 v[64:65], v112 offset:16384
    ds_read_b64_tr_b16 v[66:67], v112 offset:16640
    buffer_load_dwordx4 v117, s[4:7], s3 offen offset:1024 lds
    v_mfma_f32_32x32x16_bf16 v[32:47], v[76:79], v[176:179], v[32:47]
    ds_read_b64_tr_b16 v[68:69], v112 offset:49152
    ds_read_b64_tr_b16 v[70:71], v112 offset:49408
    v_mfma_f32_32x32x16_bf16 v[16:31], a[24:27], v[180:183], v[16:31]
    ds_read_b64_tr_b16 a[0:1], v113 offset:16384
    ds_read_b64_tr_b16 a[2:3], v113 offset:16640
    buffer_load_dwordx4 v118, s[4:7], s3 offen offset:2048 lds
    v_mfma_f32_32x32x16_bf16 v[32:47], a[28:31], v[180:183], v[32:47]
    s_waitcnt vmcnt(17)
    ds_read_b64_tr_b16 a[4:5], v113 offset:49152
    ds_read_b64_tr_b16 a[6:7], v113 offset:49408
    ds_read_b128 v[192:195], v6 offset:16384
    v_mfma_f32_32x32x16_bf16 v[16:31], a[32:35], v[184:187], v[16:31]
    ds_read_b64_tr_b16 a[8:9], v114 offset:16384
    ds_read_b64_tr_b16 a[10:11], v114 offset:16640
    ds_read_b128 v[196:199], v7 offset:16384
    v_mfma_f32_32x32x16_bf16 v[32:47], a[36:39], v[184:187], v[32:47]
    ds_read_b64_tr_b16 a[12:13], v114 offset:49152
    ds_read_b64_tr_b16 a[14:15], v114 offset:49408
    ds_read_b128 v[200:203], v8 offset:16384
    v_mfma_f32_32x32x16_bf16 v[16:31], a[40:43], v[188:191], v[16:31]
    ds_read_b64_tr_b16 a[16:17], v115 offset:16384
    ds_read_b64_tr_b16 a[18:19], v115 offset:16640
    ds_read_b128 v[204:207], v9 offset:16384
    v_mfma_f32_32x32x16_bf16 v[32:47], a[44:47], v[188:191], v[32:47]
    ds_read_b64_tr_b16 a[20:21], v115 offset:49152
    ds_read_b64_tr_b16 a[22:23], v115 offset:49408
    buffer_load_dwordx4 v119, s[4:7], s3 offen offset:3072 lds
    v_dot2c_f32_bf16 v96, s70, v176
    s_add_u32 m0, s57, 8192
    s_add_u32 s3, s3, 128
    s_and_b32 s3, s3, 0x3ff
    buffer_load_dwordx4 v116, s[4:7], s3 offen lds
    v_dot2c_f32_bf16 v98, v176, v176
    buffer_load_dwordx4 v117, s[4:7], s3 offen offset:1024 lds
    v_dot2c_f32_bf16 v97, s70, v177
    buffer_load_dwordx4 v118, s[4:7], s3 offen offset:2048 lds
    v_dot2c_f32_bf16 v99, v177, v177
    v_dot2c_f32_bf16 v96, s70, v178
    v_dot2c_f32_bf16 v98, v178, v178
    v_dot2c_f32_bf16 v97, s70, v179
    v_dot2c_f32_bf16 v99, v179, v179
    v_dot2c_f32_bf16 v96, s70, v180
    v_dot2c_f32_bf16 v98, v180, v180
    v_dot2c_f32_bf16 v97, s70, v181
    v_dot2c_f32_bf16 v99, v181, v181
    v_dot2c_f32_bf16 v96, s70, v182
    v_dot2c_f32_bf16 v98, v182, v182
    v_dot2c_f32_bf16 v97, s70, v183
    buffer_load_dwordx4 v119, s[4:7], s3 offen offset:3072 lds
    v_dot2c_f32_bf16 v99, v183, v183
    v_dot2c_f32_bf16 v96, s70, v184
    v_dot2c_f32_bf16 v98, v184, v184
    v_dot2c_f32_bf16 v97, s70, v185
    v_dot2c_f32_bf16 v99, v185, v185
    v_dot2c_f32_bf16 v96, s70, v186
    v_dot2c_f32_bf16 v98, v186, v186
    v_dot2c_f32_bf16 v97, s70, v187
    v_dot2c_f32_bf16 v99, v187, v187
    v_dot2c_f32_bf16 v96, s70, v188
    v_dot2c_f32_bf16 v98, v188, v188
    v_dot2c_f32_bf16 v97, s70, v189
    s_add_u32 m0, s57, 12288
    s_lshl_b32 s3, s48, 1
    s_add_u32 s3, s3, s55
    s_and_b32 s3, s3, 7
    s_mul_i32 s3, s3, 196608
    buffer_load_dwordx4 v122, s[8:11], s3 offen lds
    v_dot2c_f32_bf16 v99, v189, v189
    v_dot2c_f32_bf16 v96, s70, v190
    v_dot2c_f32_bf16 v98, v190, v190
    v_dot2c_f32_bf16 v97, s70, v191
    v_dot2c_f32_bf16 v99, v191, v191
    s_waitcnt lgkmcnt(0)
    v_dot2c_f32_bf16 v100, s70, v64
    v_dot2c_f32_bf16 v101, s70, v68
    v_dot2c_f32_bf16 v100, s70, v65
    v_dot2c_f32_bf16 v101, s70, v69
    v_dot2c_f32_bf16 v100, s70, v66
    v_dot2c_f32_bf16 v101, s70, v70
    v_dot2c_f32_bf16 v100, s70, v67
    v_dot2c_f32_bf16 v101, s70, v71
    v_mfma_f32_32x32x16_bf16 v[16:31], v[64:67], v[192:195], v[16:31]
    v_mfma_f32_32x32x16_bf16 v[32:47], v[68:71], v[192:195], v[32:47]
    s_waitcnt vmcnt(9)
    s_barrier
    ds_read_b64_tr_b16 v[72:73], v112 offset:20480
    ds_read_b64_tr_b16 v[74:75], v112 offset:20736
    ds_read_b64_tr_b16 v[76:77], v112 offset:53248
    ds_read_b64_tr_b16 v[78:79], v112 offset:53504
    ds_read_b128 v[208:211], v6
    ds_read_b128 v[212:215], v7
    v_mfma_f32_32x32x16_bf16 v[16:31], a[0:3], v[196:199], v[16:31]
    ds_read_b64_tr_b16 a[24:25], v113 offset:20480
    ds_read_b64_tr_b16 a[26:27], v113 offset:20736
    ds_read_b128 v[216:219], v8
    v_mfma_f32_32x32x16_bf16 v[32:47], a[4:7], v[196:199], v[32:47]
    ds_read_b64_tr_b16 a[28:29], v113 offset:53248
    ds_read_b64_tr_b16 a[30:31], v113 offset:53504
    ds_read_b128 v[220:223], v9
    v_mfma_f32_32x32x16_bf16 v[16:31], a[8:11], v[200:203], v[16:31]
    ds_read_b64_tr_b16 a[32:33], v114 offset:20480
    ds_read_b64_tr_b16 a[34:35], v114 offset:20736
    s_add_u32 s3, s3, 48128
    buffer_load_dwordx4 v122, s[8:11], s3 offen offset:1024 lds
    v_mfma_f32_32x32x16_bf16 v[32:47], a[12:15], v[200:203], v[32:47]
    ds_read_b64_tr_b16 a[36:37], v114 offset:53248
    ds_read_b64_tr_b16 a[38:39], v114 offset:53504
    s_add_u32 s3, s3, 48128
    buffer_load_dwordx4 v122, s[8:11], s3 offen offset:2048 lds
    v_mfma_f32_32x32x16_bf16 v[16:31], a[16:19], v[204:207], v[16:31]
    ds_read_b64_tr_b16 a[40:41], v115 offset:20480
    ds_read_b64_tr_b16 a[42:43], v115 offset:20736
    v_mfma_f32_32x32x16_bf16 v[32:47], a[20:23], v[204:207], v[32:47]
    ds_read_b64_tr_b16 a[44:45], v115 offset:53248
    ds_read_b64_tr_b16 a[46:47], v115 offset:53504
    s_add_u32 s3, s3, 48128
    buffer_load_dwordx4 v122, s[8:11], s3 offen offset:3072 lds
    v_dot2c_f32_bf16 v96, s70, v192
    v_dot2c_f32_bf16 v98, v192, v192
    v_dot2c_f32_bf16 v97, s70, v193
    v_dot2c_f32_bf16 v99, v193, v193
    v_dot2c_f32_bf16 v96, s70, v194
    v_dot2c_f32_bf16 v98, v194, v194
    v_dot2c_f32_bf16 v97, s70, v195
    v_dot2c_f32_bf16 v99, v195, v195
    v_dot2c_f32_bf16 v96, s70, v196
    v_dot2c_f32_bf16 v98, v196, v196
    v_dot2c_f32_bf16 v97, s70, v197
    v_dot2c_f32_bf16 v99, v197, v197
    v_dot2c_f32_bf16 v96, s70, v198
    v_dot2c_f32_bf16 v98, v198, v198
    v_dot2c_f32_bf16 v97, s70, v199
    v_dot2c_f32_bf16 v99, v199, v199
    v_dot2c_f32_bf16 v96, s70, v200
    v_dot2c_f32_bf16 v98, v200, v200
    v_dot2c_f32_bf16 v97, s70, v201
    v_dot2c_f32_bf16 v99, v201, v201
    v_dot2c_f32_bf16 v96, s70, v202
    v_dot2c_f32_bf16 v98, v202, v202
    s_add_u32 m0, s57, 16384
    s_lshl_b32 s3, s48, 1
    s_add_u32 s3, s3, s55
    s_add_u32 s3, s3, 1
    s_and_b32 s3, s3, 7
    s_mul_i32 s3, s3, 196608
    buffer_load_dwordx4 v122, s[8:11], s3 offen lds
    v_dot2c_f32_bf16 v97, s70, v203
    v_dot2c_f32_bf16 v99, v203, v203
    v_dot2c_f32_bf16 v96, s70, v204
    v_dot2c_f32_bf16 v98, v204, v204
    v_dot2c_f32_bf16 v97, s70, v205
    v_dot2c_f32_bf16 v99, v205, v205
    v_dot2c_f32_bf16 v96, s70, v206
    v_dot2c_f32_bf16 v98, v206, v206
    v_dot2c_f32_bf16 v97, s70, v207
    v_dot2c_f32_bf16 v99, v207, v207
    s_waitcnt lgkmcnt(0)
    v_dot2c_f32_bf16 v100, s70, v72
    v_dot2c_f32_bf16 v101, s70, v76
    v_dot2c_f32_bf16 v100, s70, v73
    v_dot2c_f32_bf16 v101, s70, v77
    v_dot2c_f32_bf16 v100, s70, v74
    v_dot2c_f32_bf16 v101, s70, v78
    v_dot2c_f32_bf16 v100, s70, v75
    v_dot2c_f32_bf16 v101, s70, v79
    v_mfma_f32_32x32x16_bf16 v[16:31], v[72:75], v[208:211], v[16:31]
    ds_read_b64_tr_b16 v[64:65], v112 offset:24576
    ds_read_b64_tr_b16 v[66:67], v112 offset:24832
    s_add_u32 s3, s3, 48128
    buffer_load_dwordx4 v122, s[8:11], s3 offen offset:1024 lds
    v_mfma_f32_32x32x16_bf16 v[32:47], v[76:79], v[208:211], v[32:47]
    ds_read_b64_tr_b16 v[68:69], v112 offset:57344
    ds_read_b64_tr_b16 v[70:71], v112 offset:57600
    v_mfma_f32_32x32x16_bf16 v[16:31], a[24:27], v[212:215], v[16:31]
    ds_read_b64_tr_b16 a[0:1], v113 offset:24576
    ds_read_b64_tr_b16 a[2:3], v113 offset:24832
    v_mfma_f32_32x32x16_bf16 v[32:47], a[28:31], v[212:215], v[32:47]
    s_waitcnt vmcnt(10)
    ds_read_b64_tr_b16 a[4:5], v113 offset:57344
    ds_read_b64_tr_b16 a[6:7], v113 offset:57600
    ds_read_b128 v[224:227], v6 offset:4096
    v_mfma_f32_32x32x16_bf16 v[16:31], a[32:35], v[216:219], v[16:31]
    ds_read_b64_tr_b16 a[8:9], v114 offset:24576
    ds_read_b64_tr_b16 a[10:11], v114 offset:24832
    ds_read_b128 v[228:231], v7 offset:4096
    v_mfma_f32_32x32x16_bf16 v[32:47], a[36:39], v[216:219], v[32:47]
    ds_read_b64_tr_b16 a[12:13], v114 offset:57344
    ds_read_b64_tr_b16 a[14:15], v114 offset:57600
    ds_read_b128 v[232:235], v8 offset:4096
    v_mfma_f32_32x32x16_bf16 v[16:31], a[40:43], v[220:223], v[16:31]
    ds_read_b64_tr_b16 a[16:17], v115 offset:24576
    ds_read_b64_tr_b16 a[18:19], v115 offset:24832
    ds_read_b128 v[236:239], v9 offset:4096
    v_mfma_f32_32x32x16_bf16 v[32:47], a[44:47], v[220:223], v[32:47]
    ds_read_b64_tr_b16 a[20:21], v115 offset:57344
    ds_read_b64_tr_b16 a[22:23], v115 offset:57600
    s_add_u32 s3, s3, 48128
    buffer_load_dwordx4 v122, s[8:11], s3 offen offset:2048 lds
    v_dot2c_f32_bf16 v96, s70, v208
    s_add_u32 s3, s3, 48128
    buffer_load_dwordx4 v122, s[8:11], s3 offen offset:3072 lds
    v_dot2c_f32_bf16 v98, v208, v208
    v_dot2c_f32_bf16 v97, s70, v209
    v_dot2c_f32_bf16 v99, v209, v209
    v_dot2c_f32_bf16 v96, s70, v210
    v_dot2c_f32_bf16 v98, v210, v210
    v_dot2c_f32_bf16 v97, s70, v211
    v_dot2c_f32_bf16 v99, v211, v211
    v_dot2c_f32_bf16 v96, s70, v212
    v_dot2c_f32_bf16 v98, v212, v212
    v_dot2c_f32_bf16 v97, s70, v213
    v_dot2c_f32_bf16 v99, v213, v213
    v_dot2c_f32_bf16 v96, s70, v214
    v_dot2c_f32_bf16 v98, v214, v214
    v_dot2c_f32_bf16 v97, s70, v215
    v_dot2c_f32_bf16 v99, v215, v215
    v_dot2c_f32_bf16 v96, s70, v216
    v_dot2c_f32_bf16 v98, v216, v216
    v_dot2c_f32_bf16 v97, s70, v217
    v_dot2c_f32_bf16 v99, v217, v217
    v_dot2c_f32_bf16 v96, s70, v218
    v_dot2c_f32_bf16 v98, v218, v218
    v_dot2c_f32_bf16 v97, s70, v219
    v_dot2c_f32_bf16 v99, v219, v219
    v_dot2c_f32_bf16 v96, s70, v220
    v_dot2c_f32_bf16 v98, v220, v220
    v_dot2c_f32_bf16 v97, s70, v221
    v_dot2c_f32_bf16 v99, v221, v221
    v_dot2c_f32_bf16 v96, s70, v222
    v_dot2c_f32_bf16 v98, v222, v222
    v_dot2c_f32_bf16 v97, s70, v223
    v_dot2c_f32_bf16 v99, v223, v223
    s_waitcnt lgkmcnt(0)
    v_dot2c_f32_bf16 v100, s70, v64
    v_dot2c_f32_bf16 v101, s70, v68
    v_dot2c_f32_bf16 v100, s70, v65
    v_dot2c_f32_bf16 v101, s70, v69
    v_dot2c_f32_bf16 v100, s70, v66
    v_dot2c_f32_bf16 v101, s70, v70
    v_dot2c_f32_bf16 v100, s70, v67
    v_dot2c_f32_bf16 v101, s70, v71
    v_mfma_f32_32x32x16_bf16 v[16:31], v[64:67], v[224:227], v[16:31]
    ds_read_b64_tr_b16 v[72:73], v112 offset:28672
    ds_read_b64_tr_b16 v[74:75], v112 offset:28928
    v_mfma_f32_32x32x16_bf16 v[32:47], v[68:71], v[224:227], v[32:47]
    ds_read_b64_tr_b16 v[76:77], v112 offset:61440
    ds_read_b64_tr_b16 v[78:79], v112 offset:61696
    v_mfma_f32_32x32x16_bf16 v[16:31], a[0:3], v[228:231], v[16:31]
    ds_read_b64_tr_b16 a[24:25], v113 offset:28672
    ds_read_b64_tr_b16 a[26:27], v113 offset:28928
    v_mfma_f32_32x32x16_bf16 v[32:47], a[4:7], v[228:231], v[32:47]
    s_waitcnt vmcnt(8)
    ds_read_b64_tr_b16 a[28:29], v113 offset:61440
    ds_read_b64_tr_b16 a[30:31], v113 offset:61696
    ds_read_b128 v[240:243], v6 offset:8192
    v_mfma_f32_32x32x16_bf16 v[16:31], a[8:11], v[232:235], v[16:31]
    ds_read_b64_tr_b16 a[32:33], v114 offset:28672
    ds_read_b64_tr_b16 a[34:35], v114 offset:28928
    ds_read_b128 v[244:247], v7 offset:8192
    v_mfma_f32_32x32x16_bf16 v[32:47], a[12:15], v[232:235], v[32:47]
    ds_read_b64_tr_b16 a[36:37], v114 offset:61440
    ds_read_b64_tr_b16 a[38:39], v114 offset:61696
    ds_read_b128 v[248:251], v8 offset:8192
    v_mfma_f32_32x32x16_bf16 v[16:31], a[16:19], v[236:239], v[16:31]
    ds_read_b64_tr_b16 a[40:41], v115 offset:28672
    ds_read_b64_tr_b16 a[42:43], v115 offset:28928
    ds_read_b128 v[252:255], v9 offset:8192
    v_mfma_f32_32x32x16_bf16 v[32:47], a[20:23], v[236:239], v[32:47]
    ds_read_b64_tr_b16 a[44:45], v115 offset:61440
    ds_read_b64_tr_b16 a[46:47], v115 offset:61696
    v_dot2c_f32_bf16 v96, s70, v224
    v_dot2c_f32_bf16 v98, v224, v224
    v_dot2c_f32_bf16 v97, s70, v225
    v_dot2c_f32_bf16 v99, v225, v225
    v_dot2c_f32_bf16 v96, s70, v226
    v_dot2c_f32_bf16 v98, v226, v226
    v_dot2c_f32_bf16 v97, s70, v227
    v_dot2c_f32_bf16 v99, v227, v227
    v_dot2c_f32_bf16 v96, s70, v228
    v_dot2c_f32_bf16 v98, v228, v228
    v_dot2c_f32_bf16 v97, s70, v229
    v_dot2c_f32_bf16 v99, v229, v229
    v_dot2c_f32_bf16 v96, s70, v230
    v_dot2c_f32_bf16 v98, v230, v230
    v_dot2c_f32_bf16 v97, s70, v231
    v_dot2c_f32_bf16 v99, v231, v231
    v_dot2c_f32_bf16 v96, s70, v232
    v_dot2c_f32_bf16 v98, v232, v232
    v_dot2c_f32_bf16 v97, s70, v233
    v_dot2c_f32_bf16 v99, v233, v233
    v_dot2c_f32_bf16 v96, s70, v234
    v_dot2c_f32_bf16 v98, v234, v234
    v_dot2c_f32_bf16 v97, s70, v235
    v_dot2c_f32_bf16 v99, v235, v235
    v_dot2c_f32_bf16 v96, s70, v236
    v_dot2c_f32_bf16 v98, v236, v236
    v_dot2c_f32_bf16 v97, s70, v237
    v_dot2c_f32_bf16 v99, v237, v237
    v_dot2c_f32_bf16 v96, s70, v238
    v_dot2c_f32_bf16 v98, v238, v238
    v_dot2c_f32_bf16 v97, s70, v239
    v_dot2c_f32_bf16 v99, v239, v239
    s_waitcnt lgkmcnt(0)
    v_dot2c_f32_bf16 v100, s70, v72
    v_dot2c_f32_bf16 v101, s70, v76
    v_dot2c_f32_bf16 v100, s70, v73
    v_dot2c_f32_bf16 v101, s70, v77
    v_dot2c_f32_bf16 v100, s70, v74
    v_dot2c_f32_bf16 v101, s70, v78
    v_dot2c_f32_bf16 v100, s70, v75
    v_dot2c_f32_bf16 v101, s70, v79
    v_dot2c_f32_bf16 v96, s70, v240
    v_dot2c_f32_bf16 v98, v240, v240
    v_dot2c_f32_bf16 v97, s70, v241
    v_dot2c_f32_bf16 v99, v241, v241
    v_dot2c_f32_bf16 v96, s70, v242
    v_dot2c_f32_bf16 v98, v242, v242
    v_dot2c_f32_bf16 v97, s70, v243
    v_dot2c_f32_bf16 v99, v243, v243
    v_dot2c_f32_bf16 v96, s70, v244
    v_dot2c_f32_bf16 v98, v244, v244
    v_dot2c_f32_bf16 v97, s70, v245
    v_dot2c_f32_bf16 v99, v245, v245
    v_dot2c_f32_bf16 v96, s70, v246
    v_dot2c_f32_bf16 v98, v246, v246
    v_dot2c_f32_bf16 v97, s70, v247
    v_dot2c_f32_bf16 v99, v247, v247
    v_dot2c_f32_bf16 v96, s70, v248
    v_dot2c_f32_bf16 v98, v248, v248
    v_dot2c_f32_bf16 v97, s70, v249
    v_dot2c_f32_bf16 v99, v249, v249
    v_dot2c_f32_bf16 v96, s70, v250
    v_dot2c_f32_bf16 v98, v250, v250
    v_dot2c_f32_bf16 v97, s70, v251
    v_dot2c_f32_bf16 v99, v251, v251
    v_dot2c_f32_bf16 v96, s70, v252
    v_dot2c_f32_bf16 v98, v252, v252
    v_dot2c_f32_bf16 v97, s70, v253
    v_dot2c_f32_bf16 v99, v253, v253
    v_dot2c_f32_bf16 v96, s70, v254
    v_dot2c_f32_bf16 v98, v254, v254
    v_dot2c_f32_bf16 v97, s70, v255
    v_dot2c_f32_bf16 v99, v255, v255
    v_permlane32_swap_b32 v100, v101
    v_add_f32 v100, v100, v101
    ds_write_b32 v12, v100
    v_mfma_f32_32x32x16_bf16 v[16:31], v[72:75], v[240:243], v[16:31]
    s_cmp_ge_u32 s61, 56
    s_cbranch_scc1 L_norl1
    s_add_u32 m0, s57, 8192
    s_add_u32 s3, s59, 7168
    buffer_load_dwordx4 v11, s[24:27], s59 offen lds
    buffer_load_dwordx4 v11, s[24:27], s3 offen offset:1024 lds
    s_sub_u32 s3, s60, 2048
    s_add_u32 s71, s60, 5120
    buffer_load_dwordx4 v11, s[24:27], s3 offen offset:2048 lds
    buffer_load_dwordx4 v11, s[24:27], s71 offen offset:3072 lds
L_norl1:
    s_waitcnt lgkmcnt(0)
    s_barrier
    ds_read_b128 v[48:51], v13
    v_mfma_f32_32x32x16_bf16 v[16:31], a[24:27], v[244:247], v[16:31]
    v_add_f32 v96, v96, v97
    v_add_f32 v98, v98, v99
    v_mov_b32 v97, v96
    v_mov_b32 v99, v98
    s_nop 0
    v_permlane32_swap_b32 v96, v97
    v_permlane32_swap_b32 v98, v99
    v_add_f32 v96, v96, v97
    v_add_f32 v98, v98, v99
    v_mul_f32 v96, 0xbb000000, v96
    v_mul_f32 v98, 0x3b000000, v98
    v_fma_f32 v98, -v96, v96, v98
    v_max_f32 v98, 0, v98
    v_add_f32 v98, 0x3727c5ac, v98
    v_rsq_f32 v98, v98
    s_nop 0
    v_mul_f32 v100, 0x3fb8aa3b, v98
    v_mul_f32 v101, 0xbfb8aa3b, v98
    v_mfma_f32_32x32x16_bf16 v[16:31], a[32:35], v[248:251], v[16:31]
    s_waitcnt lgkmcnt(0)
    v_add_f32 v48, v48, v49
    v_add_f32 v50, v50, v51
    v_add_f32 v48, v48, v50
    ds_write_b32 v14, v48
    v_mfma_f32_32x32x16_bf16 v[16:31], a[40:43], v[252:255], v[16:31]
    ds_read_b128 v[48:51], v10
    ds_read_b128 v[52:55], v10 offset:32
    ds_read_b128 v[56:59], v10 offset:64
    ds_read_b128 v[60:63], v10 offset:96
    v_mfma_f32_32x32x16_bf16 v[32:47], v[76:79], v[240:243], v[32:47]
    ds_read_b128 v[112:115], v10 offset:128
    ds_read_b128 v[116:119], v10 offset:160
    ds_read_b128 v[120:123], v10 offset:192
    ds_read_b128 v[124:127], v10 offset:224
    v_mfma_f32_32x32x16_bf16 v[32:47], a[28:31], v[244:247], v[32:47]
    s_add_u32 m0, s52, 0
    s_add_u32 s3, s56, 0
    buffer_load_dwordx4 v11, s[16:19], s3 offen lds
    s_waitcnt lgkmcnt(4)
    v_mfma_f32_32x32x16_bf16 v[32:47], a[36:39], v[248:251], v[32:47]
    v_fmac_f32 v16, v96, v48
    v_fmac_f32 v17, v96, v49
    v_fmac_f32 v18, v96, v50
    v_fmac_f32 v19, v96, v51
    v_fmac_f32 v20, v96, v52
    v_fmac_f32 v21, v96, v53
    v_mfma_f32_32x32x16_bf16 v[32:47], a[44:47], v[252:255], v[32:47]
    v_fmac_f32 v22, v96, v54
    v_fmac_f32 v23, v96, v55
    v_fmac_f32 v24, v96, v56
    v_fmac_f32 v25, v96, v57
    v_fmac_f32 v26, v96, v58
    v_fmac_f32 v27, v96, v59
    v_fmac_f32 v28, v96, v60
    v_fmac_f32 v29, v96, v61
    v_fmac_f32 v30, v96, v62
    v_fmac_f32 v31, v96, v63
    v_cvt_pk_bf16_f32 v48, v16, v17
    v_cvt_pk_bf16_f32 v49, v18, v19
    v_cvt_pk_bf16_f32 v50, v20, v21
    v_cvt_pk_bf16_f32 v51, v22, v23
    v_cvt_pk_bf16_f32 v52, v24, v25
    v_cvt_pk_bf16_f32 v53, v26, v27
    v_cvt_pk_bf16_f32 v54, v28, v29
    v_cvt_pk_bf16_f32 v55, v30, v31
    v_mfma_f32_32x32x16_bf16 v[64:79], v[104:107], v[48:51], 0
    s_add_u32 m0, s52, 4096
    s_add_u32 s3, s56, 32768
    buffer_load_dwordx4 v11, s[16:19], s3 offen lds
    v_mfma_f32_32x32x16_bf16 v[80:95], v[108:111], v[52:55], 0
    s_add_u32 m0, s52, 8192
    s_add_u32 s3, s56, 65536
    buffer_load_dwordx4 v11, s[16:19], s3 offen lds
    s_waitcnt lgkmcnt(0)
    v_fmac_f32 v32, v96, v112
    v_fmac_f32 v33, v96, v113
    v_fmac_f32 v34, v96, v114
    v_fmac_f32 v35, v96, v115
    v_fmac_f32 v36, v96, v116
    v_fmac_f32 v37, v96, v117
    v_fmac_f32 v38, v96, v118
    v_fmac_f32 v39, v96, v119
    v_fmac_f32 v40, v96, v120
    v_fmac_f32 v41, v96, v121
    v_fmac_f32 v42, v96, v122
    v_fmac_f32 v43, v96, v123
    v_fmac_f32 v44, v96, v124
    v_fmac_f32 v45, v96, v125
    v_fmac_f32 v46, v96, v126
    v_fmac_f32 v47, v96, v127
    v_pk_mul_f32 v[32:33], v[32:33], v[98:99] op_sel_hi:[1,0]
    v_pk_mul_f32 v[34:35], v[34:35], v[98:99] op_sel_hi:[1,0]
    v_pk_mul_f32 v[36:37], v[36:37], v[98:99] op_sel_hi:[1,0]
    v_pk_mul_f32 v[38:39], v[38:39], v[98:99] op_sel_hi:[1,0]
    v_pk_mul_f32 v[40:41], v[40:41], v[98:99] op_sel_hi:[1,0]
    v_pk_mul_f32 v[42:43], v[42:43], v[98:99] op_sel_hi:[1,0]
    v_pk_mul_f32 v[44:45], v[44:45], v[98:99] op_sel_hi:[1,0]
    v_pk_mul_f32 v[46:47], v[46:47], v[98:99] op_sel_hi:[1,0]
    v_cvt_pk_bf16_f32 v56, v32, v33
    v_cvt_pk_bf16_f32 v57, v34, v35
    v_cvt_pk_bf16_f32 v58, v36, v37
    v_cvt_pk_bf16_f32 v59, v38, v39
    v_cvt_pk_bf16_f32 v60, v40, v41
    v_cvt_pk_bf16_f32 v61, v42, v43
    v_cvt_pk_bf16_f32 v62, v44, v45
    v_cvt_pk_bf16_f32 v63, v46, v47
    ds_write_b128 v2, v[56:59] offset:4096
    ds_write_b128 v2, v[60:63] offset:5120
    v_max3_f32 v16, v64, v65, v66
    s_add_u32 m0, s52, 12288
    s_add_u32 s3, s56, 98304
    buffer_load_dwordx4 v11, s[16:19], s3 offen lds
    v_max3_f32 v18, v80, v81, v82
    s_add_u32 m0, s52, 16384
    s_add_u32 s3, s56, 131072
    buffer_load_dwordx4 v11, s[16:19], s3 offen lds
    v_max3_f32 v16, v16, v67, v68
    s_add_u32 m0, s52, 20480
    s_add_u32 s3, s56, 163840
    buffer_load_dwordx4 v11, s[16:19], s3 offen lds
    v_max3_f32 v18, v18, v83, v84
    s_add_u32 m0, s52, 24576
    s_add_u32 s3, s56, 196608
    buffer_load_dwordx4 v11, s[16:19], s3 offen lds
    v_max3_f32 v16, v16, v69, v70
    v_max3_f32 v18, v18, v85, v86
    v_max3_f32 v16, v16, v71, v72
    v_max3_f32 v18, v18, v87, v88
    v_max3_f32 v16, v16, v73, v74
    v_max3_f32 v18, v18, v89, v90
    v_max3_f32 v16, v16, v75, v76
    v_max3_f32 v18, v18, v91, v92
    v_max3_f32 v16, v16, v77, v78
    v_max3_f32 v18, v18, v93, v94
    v_max_f32 v16, v16, v79
    v_max_f32 v18, v18, v95
    v_mul_f32 v16, v16, v101
    v_mul_f32 v18, v18, v101
    v_pk_fma_f32 v[64:65], v[64:65], v[100:101], v[16:17] op_sel_hi:[1,0,0]
    v_pk_fma_f32 v[66:67], v[66:67], v[100:101], v[16:17] op_sel_hi:[1,0,0]
    v_pk_fma_f32 v[68:69], v[68:69], v[100:101], v[16:17] op_sel_hi:[1,0,0]
    v_pk_fma_f32 v[70:71], v[70:71], v[100:101], v[16:17] op_sel_hi:[1,0,0]
    v_pk_fma_f32 v[72:73], v[72:73], v[100:101], v[16:17] op_sel_hi:[1,0,0]
    v_pk_fma_f32 v[74:75], v[74:75], v[100:101], v[16:17] op_sel_hi:[1,0,0]
    v_pk_fma_f32 v[76:77], v[76:77], v[100:101], v[16:17] op_sel_hi:[1,0,0]
    v_pk_fma_f32 v[78:79], v[78:79], v[100:101], v[16:17] op_sel_hi:[1,0,0]
    v_pk_fma_f32 v[80:81], v[80:81], v[100:101], v[18:19] op_sel_hi:[1,0,0]
    v_pk_fma_f32 v[82:83], v[82:83], v[100:101], v[18:19] op_sel_hi:[1,0,0]
    v_pk_fma_f32 v[84:85], v[84:85], v[100:101], v[18:19] op_sel_hi:[1,0,0]
    v_pk_fma_f32 v[86:87], v[86:87], v[100:101], v[18:19] op_sel_hi:[1,0,0]
    v_pk_fma_f32 v[88:89], v[88:89], v[100:101], v[18:19] op_sel_hi:[1,0,0]
    v_pk_fma_f32 v[90:91], v[90:91], v[100:101], v[18:19] op_sel_hi:[1,0,0]
    v_pk_fma_f32 v[92:93], v[92:93], v[100:101], v[18:19] op_sel_hi:[1,0,0]
    v_pk_fma_f32 v[94:95], v[94:95], v[100:101], v[18:19] op_sel_hi:[1,0,0]
    v_exp_f32 v64, v64
    v_exp_f32 v65, v65
    v_exp_f32 v66, v66
    v_exp_f32 v67, v67
    v_exp_f32 v68, v68
    v_exp_f32 v69, v69
    v_exp_f32 v70, v70
    v_exp_f32 v71, v71
    v_exp_f32 v72, v72
    v_exp_f32 v73, v73
    v_exp_f32 v74, v74
    v_exp_f32 v75, v75
    v_exp_f32 v76, v76
    v_exp_f32 v77, v77
    v_exp_f32 v78, v78
    v_exp_f32 v79, v79
    v_exp_f32 v80, v80
    v_exp_f32 v81, v81
    v_exp_f32 v82, v82
    v_exp_f32 v83, v83
    v_exp_f32 v84, v84
    v_exp_f32 v85, v85
    v_exp_f32 v86, v86
    v_exp_f32 v87, v87
    v_exp_f32 v88, v88
    v_exp_f32 v89, v89
    v_exp_f32 v90, v90
    v_exp_f32 v91, v91
    v_exp_f32 v92, v92
    v_exp_f32 v93, v93
    v_exp_f32 v94, v94
    v_exp_f32 v95, v95
    v_pk_add_f32 v[20:21], v[64:65], v[66:67]
    v_pk_add_f32 v[28:29], v[80:81], v[82:83]
    v_pk_add_f32 v[22:23], v[68:69], v[70:71]
    v_pk_add_f32 v[30:31], v[84:85], v[86:87]
    v_pk_add_f32 v[24:25], v[72:73], v[74:75]
    v_pk_add_f32 v[32:33], v[88:89], v[90:91]
    v_pk_add_f32 v[26:27], v[76:77], v[78:79]
    v_pk_add_f32 v[34:35], v[92:93], v[94:95]
    v_pk_add_f32 v[20:21], v[20:21], v[22:23]
    v_pk_add_f32 v[28:29], v[28:29], v[30:31]
    v_pk_add_f32 v[24:25], v[24:25], v[26:27]
    v_pk_add_f32 v[32:33], v[32:33], v[34:35]
    v_pk_add_f32 v[20:21], v[20:21], v[24:25]
    v_pk_add_f32 v[28:29], v[28:29], v[32:33]
    v_add_f32 v20, v20, v21
    v_add_f32 v28, v28, v29
    v_rcp_f32 v20, v20
    v_rcp_f32 v28, v28
    v_pk_mul_f32 v[64:65], v[64:65], v[20:21] op_sel_hi:[1,0]
    v_pk_mul_f32 v[66:67], v[66:67], v[20:21] op_sel_hi:[1,0]
    v_pk_mul_f32 v[68:69], v[68:69], v[20:21] op_sel_hi:[1,0]
    v_pk_mul_f32 v[70:71], v[70:71], v[20:21] op_sel_hi:[1,0]
    v_pk_mul_f32 v[72:73], v[72:73], v[20:21] op_sel_hi:[1,0]
    v_pk_mul_f32 v[74:75], v[74:75], v[20:21] op_sel_hi:[1,0]
    v_pk_mul_f32 v[76:77], v[76:77], v[20:21] op_sel_hi:[1,0]
    v_pk_mul_f32 v[78:79], v[78:79], v[20:21] op_sel_hi:[1,0]
    v_pk_mul_f32 v[80:81], v[80:81], v[28:29] op_sel_hi:[1,0]
    v_pk_mul_f32 v[82:83], v[82:83], v[28:29] op_sel_hi:[1,0]
    v_pk_mul_f32 v[84:85], v[84:85], v[28:29] op_sel_hi:[1,0]
    v_pk_mul_f32 v[86:87], v[86:87], v[28:29] op_sel_hi:[1,0]
    v_pk_mul_f32 v[88:89], v[88:89], v[28:29] op_sel_hi:[1,0]
    v_pk_mul_f32 v[90:91], v[90:91], v[28:29] op_sel_hi:[1,0]
    v_pk_mul_f32 v[92:93], v[92:93], v[28:29] op_sel_hi:[1,0]
    v_pk_mul_f32 v[94:95], v[94:95], v[28:29] op_sel_hi:[1,0]
    v_cvt_pk_bf16_f32 v32, v64, v65
    v_cvt_pk_bf16_f32 v33, v66, v67
    v_cvt_pk_bf16_f32 v34, v68, v69
    v_cvt_pk_bf16_f32 v35, v70, v71
    v_cvt_pk_bf16_f32 v36, v72, v73
    v_cvt_pk_bf16_f32 v37, v74, v75
    v_cvt_pk_bf16_f32 v38, v76, v77
    v_cvt_pk_bf16_f32 v39, v78, v79
    v_cvt_pk_bf16_f32 v40, v80, v81
    v_cvt_pk_bf16_f32 v41, v82, v83
    v_cvt_pk_bf16_f32 v42, v84, v85
    v_cvt_pk_bf16_f32 v43, v86, v87
    v_cvt_pk_bf16_f32 v44, v88, v89
    v_cvt_pk_bf16_f32 v45, v90, v91
    v_cvt_pk_bf16_f32 v46, v92, v93
    v_cvt_pk_bf16_f32 v47, v94, v95
    ds_write_b128 v3, v[32:35]
    ds_write_b128 v3, v[36:39] offset:16
    ds_write_b128 v3, v[40:43] offset:2048
    ds_write_b128 v3, v[44:47] offset:2064
    v_mov_b32 v56, s70
    v_mov_b32 v57, s70
    v_mov_b32 v58, s70
    v_mov_b32 v59, s70
    s_waitcnt vmcnt(7) lgkmcnt(0)
    s_barrier
    ds_read_b64_tr_b16 v[64:65], v4
    ds_read_b64_tr_b16 v[66:67], v4 offset:512
    ds_read_b64_tr_b16 v[68:69], v5
    ds_read_b64_tr_b16 v[70:71], v5 offset:512
    ds_read_b64_tr_b16 v[72:73], v4 offset:21504
    ds_read_b64_tr_b16 v[74:75], v4 offset:22016
    ds_read_b64_tr_b16 v[76:77], v5 offset:21504
    ds_read_b64_tr_b16 v[78:79], v5 offset:22016
    ds_read_b64_tr_b16 v[80:81], v4 offset:43008
    ds_read_b64_tr_b16 v[82:83], v4 offset:43520
    ds_read_b64_tr_b16 v[84:85], v5 offset:43008
    ds_read_b64_tr_b16 v[86:87], v5 offset:43520
    ds_read_b64_tr_b16 v[88:89], v4 offset:64512
    ds_read_b64_tr_b16 v[90:91], v4 offset:65024
    ds_read_b64_tr_b16 v[92:93], v5 offset:64512
    ds_read_b64_tr_b16 v[94:95], v5 offset:65024
    buffer_load_dword v15, off, s[36:39], 0 sc1
    s_lshl_b32 s73, s49, 2
    s_add_u32 s73, s73, s48
    s_lshl_b32 s73, s73, 4
    s_add_u32 s73, s73, s50
    s_lshl_b32 s72, s73, 9
    s_add_u32 s72, s72, 524288
    s_lshl_b32 s73, s73, 7
    s_add_u32 s73, s73, 1048576
    v_lshlrev_b32 v3, 3, v0
    s_waitcnt lgkmcnt(12)
    v_mfma_f32_16x16x32_bf16 v[48:51], v[64:67], v[68:71], 0
    v_mfma_f32_16x16x32_bf16 v[52:55], v[64:67], v[56:59], 0
    s_waitcnt lgkmcnt(8)
    v_mfma_f32_16x16x32_bf16 v[48:51], v[72:75], v[76:79], v[48:51]
    v_mfma_f32_16x16x32_bf16 v[52:55], v[72:75], v[56:59], v[52:55]
    s_waitcnt lgkmcnt(4)
    v_mfma_f32_16x16x32_bf16 v[48:51], v[80:83], v[84:87], v[48:51]
    v_mfma_f32_16x16x32_bf16 v[52:55], v[80:83], v[56:59], v[52:55]
    s_waitcnt lgkmcnt(0)
    v_mfma_f32_16x16x32_bf16 v[48:51], v[88:91], v[92:95], v[48:51]
    v_mfma_f32_16x16x32_bf16 v[52:55], v[88:91], v[56:59], v[52:55]
    v_accvgpr_read_b32 v116, a240
    v_accvgpr_read_b32 v117, a241
    v_accvgpr_read_b32 v118, a242
    v_accvgpr_read_b32 v119, a243
    v_add_u32 v120, 43008, v116
    v_add_u32 v121, 43008, v117
    v_add_u32 v122, 43008, v118
    v_add_u32 v123, 43008, v119
    v_and_b32 v2, 0x30, v0
    v_and_b32 v4, 1, v0
    v_lshl_add_u32 v2, v4, 6, v2
    v_cvt_pk_bf16_f32 v48, v48, v49
    v_cvt_pk_bf16_f32 v49, v50, v51
    buffer_store_dwordx2 v[48:49], v3, s[32:35], s72 offen sc1
    s_mov_b32 exec_lo, 0x00030003
    s_mov_b32 exec_hi, 0x00030003
    buffer_store_dwordx4 v[52:55], v2, s[32:35], s73 offen sc1
    s_mov_b64 exec, -1
    s_waitcnt vmcnt(2)
    s_cmp_ge_u32 s61, 56
    s_cbranch_scc1 L_norl2
    v_accvgpr_read_b32 v112, a251
    v_accvgpr_read_b32 v113, a252
    v_accvgpr_read_b32 v114, a253
    v_accvgpr_read_b32 v115, a254
    s_mul_i32 s72, s15, 56
    s_add_u32 s72, s72, s61
    s_lshl_b32 s72, s72, 12
    s_add_u32 s72, s72, 2097152
    ds_read_b64_tr_b16 v[32:33], v112
    ds_read_b64_tr_b16 v[34:35], v112 offset:2048
    ds_read_b64_tr_b16 v[36:37], v113
    ds_read_b64_tr_b16 v[38:39], v113 offset:2048
    ds_read_b64_tr_b16 v[40:41], v114
    ds_read_b64_tr_b16 v[42:43], v114 offset:2048
    ds_read_b64_tr_b16 v[44:45], v115
    ds_read_b64_tr_b16 v[46:47], v115 offset:2048
    s_waitcnt lgkmcnt(0)
    buffer_store_dwordx4 v[32:35], v1, s[32:35], s72 offen sc1
    buffer_store_dwordx4 v[36:39], v1, s[32:35], s72 offen offset:1024 sc1
    buffer_store_dwordx4 v[40:43], v1, s[32:35], s72 offen offset:2048 sc1
    buffer_store_dwordx4 v[44:47], v1, s[32:35], s72 offen offset:3072 sc1
L_norl2:
    ds_read_b64_tr_b16 v[64:65], v116
    ds_read_b64_tr_b16 v[66:67], v116 offset:256
    ds_read_b64_tr_b16 v[68:69], v116 offset:4096
    ds_read_b64_tr_b16 v[70:71], v116 offset:4352
    ds_read_b64_tr_b16 v[72:73], v116 offset:21504
    ds_read_b64_tr_b16 v[74:75], v116 offset:21760
    ds_read_b64_tr_b16 v[76:77], v116 offset:25600
    ds_read_b64_tr_b16 v[78:79], v116 offset:25856
    ds_read_b64_tr_b16 v[80:81], v120
    ds_read_b64_tr_b16 v[82:83], v120 offset:256
    ds_read_b64_tr_b16 v[84:85], v120 offset:4096
    ds_read_b64_tr_b16 v[86:87], v120 offset:4352
    ds_read_b64_tr_b16 v[88:89], v120 offset:21504
    ds_read_b64_tr_b16 v[90:91], v120 offset:21760
    ds_read_b64_tr_b16 v[92:93], v120 offset:25600
    ds_read_b64_tr_b16 v[94:95], v120 offset:25856
    ds_read_b64_tr_b16 a[4:5], v117
    ds_read_b64_tr_b16 a[6:7], v117 offset:256
    ds_read_b64_tr_b16 a[8:9], v118
    ds_read_b64_tr_b16 a[10:11], v118 offset:256
    ds_read_b64_tr_b16 a[12:13], v119
    ds_read_b64_tr_b16 a[14:15], v119 offset:256
    ds_read_b64_tr_b16 a[20:21], v117 offset:4096
    ds_read_b64_tr_b16 a[22:23], v117 offset:4352
    s_waitcnt lgkmcnt(15)
    v_dot2c_f32_bf16 v102, s70, v64
    v_dot2c_f32_bf16 v102, s70, v65
    v_dot2c_f32_bf16 v102, s70, v66
    v_dot2c_f32_bf16 v102, s70, v67
    v_dot2c_f32_bf16 v102, s70, v68
    v_dot2c_f32_bf16 v102, s70, v69
    v_dot2c_f32_bf16 v102, s70, v70
    v_dot2c_f32_bf16 v102, s70, v71
    v_dot2c_f32_bf16 v102, s70, v72
    v_dot2c_f32_bf16 v102, s70, v73
    v_dot2c_f32_bf16 v102, s70, v74
    v_dot2c_f32_bf16 v102, s70, v75
    v_dot2c_f32_bf16 v102, s70, v76
    v_dot2c_f32_bf16 v102, s70, v77
    v_dot2c_f32_bf16 v102, s70, v78
    v_dot2c_f32_bf16 v102, s70, v79
    ds_read_b64_tr_b16 a[24:25], v118 offset:4096
    ds_read_b64_tr_b16 a[26:27], v118 offset:4352
    ds_read_b64_tr_b16 a[28:29], v119 offset:4096
    ds_read_b64_tr_b16 a[30:31], v119 offset:4352
    ds_read_b64_tr_b16 a[36:37], v117 offset:21504
    ds_read_b64_tr_b16 a[38:39], v117 offset:21760
    ds_read_b64_tr_b16 a[40:41], v118 offset:21504
    ds_read_b64_tr_b16 a[42:43], v118 offset:21760
    ds_read_b64_tr_b16 a[44:45], v119 offset:21504
    ds_read_b64_tr_b16 a[46:47], v119 offset:21760
    ds_read_b64_tr_b16 a[52:53], v117 offset:25600
    ds_read_b64_tr_b16 a[54:55], v117 offset:25856
    ds_read_b64_tr_b16 a[56:57], v118 offset:25600
    ds_read_b64_tr_b16 a[58:59], v118 offset:25856
    ds_read_b64_tr_b16 a[60:61], v119 offset:25600
    ds_read_b64_tr_b16 a[62:63], v119 offset:25856
    s_waitcnt lgkmcnt(15)
    v_dot2c_f32_bf16 v102, s70, v80
    v_dot2c_f32_bf16 v102, s70, v81
    v_dot2c_f32_bf16 v102, s70, v82
    v_dot2c_f32_bf16 v102, s70, v83
    v_dot2c_f32_bf16 v102, s70, v84
    v_dot2c_f32_bf16 v102, s70, v85
    v_dot2c_f32_bf16 v102, s70, v86
    v_dot2c_f32_bf16 v102, s70, v87
    v_dot2c_f32_bf16 v102, s70, v88
    v_dot2c_f32_bf16 v102, s70, v89
    v_dot2c_f32_bf16 v102, s70, v90
    v_dot2c_f32_bf16 v102, s70, v91
    v_dot2c_f32_bf16 v102, s70, v92
    v_dot2c_f32_bf16 v102, s70, v93
    v_dot2c_f32_bf16 v102, s70, v94
    v_dot2c_f32_bf16 v102, s70, v95
    ds_read_b64_tr_b16 a[68:69], v121
    ds_read_b64_tr_b16 a[70:71], v121 offset:256
    ds_read_b64_tr_b16 a[72:73], v122
    ds_read_b64_tr_b16 a[74:75], v122 offset:256
    ds_read_b64_tr_b16 a[76:77], v123
    ds_read_b64_tr_b16 a[78:79], v123 offset:256
    ds_read_b64_tr_b16 a[84:85], v121 offset:4096
    ds_read_b64_tr_b16 a[86:87], v121 offset:4352
    ds_read_b64_tr_b16 a[88:89], v122 offset:4096
    ds_read_b64_tr_b16 a[90:91], v122 offset:4352
    ds_read_b64_tr_b16 a[92:93], v123 offset:4096
    ds_read_b64_tr_b16 a[94:95], v123 offset:4352
    ds_read_b64_tr_b16 a[100:101], v121 offset:21504
    ds_read_b64_tr_b16 a[102:103], v121 offset:21760
    ds_read_b64_tr_b16 a[104:105], v122 offset:21504
    ds_read_b64_tr_b16 a[106:107], v122 offset:21760
    v_mov_b32 v103, v102
    v_and_b32 v2, 31, v0
    v_lshlrev_b32 v3, 2, v2
    v_permlane32_swap_b32 v102, v103
    v_add_f32 v102, v102, v103
    s_mov_b32 exec_hi, 0
    ds_write_b32 v12, v102 offset:1024
    s_mov_b64 exec, -1
    ds_read_b64_tr_b16 a[108:109], v123 offset:21504
    ds_read_b64_tr_b16 a[110:111], v123 offset:21760
    ds_read_b64_tr_b16 a[116:117], v121 offset:25600
    ds_read_b64_tr_b16 a[118:119], v121 offset:25856
    ds_read_b64_tr_b16 a[120:121], v122 offset:25600
    ds_read_b64_tr_b16 a[122:123], v122 offset:25856
    ds_read_b64_tr_b16 a[124:125], v123 offset:25600
    ds_read_b64_tr_b16 a[126:127], v123 offset:25856
    v_lshlrev_b32 v2, 4, v2
    v_add_u32 v2, 95744, v2
    v_add_u32 v3, 94464, v3
    v_accvgpr_read_b32 v120, a244
    v_accvgpr_read_b32 v121, a245
    v_accvgpr_read_b32 v122, a246
    v_accvgpr_read_b32 v123, a247
    v_accvgpr_read_b32 v124, a248
    v_accvgpr_read_b32 v125, a249
    v_accvgpr_read_b32 v126, a250
    s_lshl_b32 s72, s49, 8
    s_add_u32 s72, s72, 0
    v_mov_b32 v127, 1
    s_cmp_lg_u32 s48, 0
    s_waitcnt vmcnt(0) lgkmcnt(0)
    s_barrier
    s_cbranch_scc1 L_arr_1
    s_mov_b64 exec, 1
    v_cmp_ne_u32 vcc, 0, v15
    s_cbranch_vccnz L_init_2_ok
    s_mov_b32 s74, 0
L_init_2:
    buffer_load_dword v15, off, s[36:39], 0 sc1
    s_add_u32 s74, s74, 1
    s_cmp_ge_u32 s74, 0x80000
    s_cbranch_scc1 L_init_2_ok
    s_waitcnt vmcnt(0)
    v_cmp_eq_u32 vcc, 0, v15
    s_cbranch_vccnz L_init_2
L_init_2_ok:
    buffer_atomic_add v127, off, s[32:35], s72 sc1
    s_mov_b64 exec, -1
L_arr_1:
    ds_read_b128 v[48:51], v2
    v_mfma_f32_32x32x16_bf16 v[16:31], v[64:67], v[128:131], 0
    v_accvgpr_read_b32 v6, a48
    v_accvgpr_read_b32 v7, a49
    v_accvgpr_read_b32 v8, a50
    v_accvgpr_read_b32 v9, a51
    v_mfma_f32_32x32x16_bf16 v[16:31], a[4:7], v[132:135], v[16:31]
    s_add_u32 m0, s52, 28672
    s_add_u32 s3, s56, 229376
    buffer_load_dwordx4 v11, s[16:19], s3 offen lds
    ds_read_b64_tr_b16 a[128:129], v6
    v_mfma_f32_32x32x16_bf16 v[16:31], a[8:11], v[136:139], v[16:31]
    s_add_u32 m0, s52, 32768
    s_add_u32 s3, s56, 262144
    buffer_load_dwordx4 v11, s[16:19], s3 offen lds
    ds_read_b64_tr_b16 a[130:131], v6 offset:1024
    v_mfma_f32_32x32x16_bf16 v[16:31], a[12:15], v[140:143], v[16:31]
    s_add_u32 m0, s52, 36864
    s_add_u32 s3, s56, 294912
    buffer_load_dwordx4 v11, s[16:19], s3 offen lds
    ds_read_b64_tr_b16 a[132:133], v7
    v_mfma_f32_32x32x16_bf16 v[16:31], v[68:71], v[144:147], v[16:31]
    s_waitcnt lgkmcnt(3)
    v_add_f32 v48, v48, v49
    v_add_f32 v50, v50, v51
    v_add_f32 v48, v48, v50
    ds_write_b32 v3, v48
    v_mfma_f32_32x32x16_bf16 v[16:31], a[20:23], v[148:151], v[16:31]
    ds_read_b128 v[48:51], v10 offset:256
    ds_read_b128 v[52:55], v10 offset:288
    ds_read_b128 v[56:59], v10 offset:320
    ds_read_b128 v[60:63], v10 offset:352
    v_mfma_f32_32x32x16_bf16 v[16:31], a[24:27], v[152:155], v[16:31]
    s_add_u32 m0, s52, 40960
    s_add_u32 s3, s56, 327680
    buffer_load_dwordx4 v11, s[16:19], s3 offen lds
    ds_read_b64_tr_b16 a[134:135], v7 offset:1024
    v_mfma_f32_32x32x16_bf16 v[16:31], a[28:31], v[156:159], v[16:31]
    s_add_u32 m0, s52, 45056
    s_add_u32 s3, s56, 360448
    buffer_load_dwordx4 v11, s[16:19], s3 offen lds
    ds_read_b64_tr_b16 a[136:137], v8
    v_mfma_f32_32x32x16_bf16 v[16:31], v[72:75], v[160:163], v[16:31]
    s_add_u32 m0, s52, 49152
    s_add_u32 s3, s56, 393216
    buffer_load_dwordx4 v11, s[16:19], s3 offen lds
    ds_read_b64_tr_b16 a[138:139], v8 offset:1024
    v_mfma_f32_32x32x16_bf16 v[16:31], a[36:39], v[164:167], v[16:31]
    s_add_u32 m0, s52, 53248
    s_add_u32 s3, s56, 425984
    buffer_load_dwordx4 v11, s[16:19], s3 offen lds
    ds_read_b64_tr_b16 a[140:141], v9
    v_mfma_f32_32x32x16_bf16 v[16:31], a[40:43], v[168:171], v[16:31]
    s_add_u32 m0, s52, 57344
    s_add_u32 s3, s56, 458752
    buffer_load_dwordx4 v11, s[16:19], s3 offen lds
    ds_read_b64_tr_b16 a[142:143], v9 offset:1024
    v_mfma_f32_32x32x16_bf16 v[16:31], a[44:47], v[172:175], v[16:31]
    ds_read_b64_tr_b16 a[144:145], v6 offset:4096
    ds_read_b64_tr_b16 a[146:147], v6 offset:5120
    ds_read_b64_tr_b16 a[148:149], v7 offset:4096
    ds_read_b64_tr_b16 a[150:151], v7 offset:5120
    v_mfma_f32_32x32x16_bf16 v[16:31], v[76:79], v[176:179], v[16:31]
    s_add_u32 m0, s52, 61440
    s_add_u32 s3, s56, 491520
    buffer_load_dwordx4 v11, s[16:19], s3 offen lds
    ds_read_b64_tr_b16 a[152:153], v8 offset:4096
    v_mfma_f32_32x32x16_bf16 v[16:31], a[52:55], v[180:183], v[16:31]
    ds_read_b64_tr_b16 a[154:155], v8 offset:5120
    ds_read_b64_tr_b16 a[156:157], v9 offset:4096
    ds_read_b64_tr_b16 a[158:159], v9 offset:5120
    ds_read_b64_tr_b16 a[160:161], v6 offset:8192
    v_mfma_f32_32x32x16_bf16 v[16:31], a[56:59], v[184:187], v[16:31]
    s_add_u32 m0, s57, 0
    s_add_u32 s3, s48, 0
    s_mul_i32 s3, s3, 114688
    buffer_load_dwordx4 v120, s[20:23], s3 offen lds
    ds_read_b64_tr_b16 a[162:163], v6 offset:9216
    v_mfma_f32_32x32x16_bf16 v[16:31], a[60:63], v[188:191], v[16:31]
    ds_read_b64_tr_b16 a[164:165], v7 offset:8192
    ds_read_b64_tr_b16 a[166:167], v7 offset:9216
    ds_read_b64_tr_b16 a[168:169], v8 offset:8192
    ds_read_b64_tr_b16 a[170:171], v8 offset:9216
    v_mfma_f32_32x32x16_bf16 v[16:31], v[80:83], v[192:195], v[16:31]
    ds_read_b64_tr_b16 a[172:173], v9 offset:8192
    ds_read_b64_tr_b16 a[174:175], v9 offset:9216
    ds_read_b64_tr_b16 a[176:177], v6 offset:12288
    ds_read_b64_tr_b16 a[178:179], v6 offset:13312
    v_mfma_f32_32x32x16_bf16 v[16:31], a[68:71], v[196:199], v[16:31]
    buffer_load_dwordx4 v121, s[20:23], s3 offen offset:1024 lds
    ds_read_b64_tr_b16 a[180:181], v7 offset:12288
    v_mfma_f32_32x32x16_bf16 v[16:31], a[72:75], v[200:203], v[16:31]
    ds_read_b64_tr_b16 a[182:183], v7 offset:13312
    ds_read_b64_tr_b16 a[184:185], v8 offset:12288
    ds_read_b64_tr_b16 a[186:187], v8 offset:13312
    ds_read_b64_tr_b16 a[188:189], v9 offset:12288
    v_mfma_f32_32x32x16_bf16 v[16:31], a[76:79], v[204:207], v[16:31]
    buffer_load_dwordx4 v122, s[20:23], s3 offen offset:2048 lds
    ds_read_b64_tr_b16 a[190:191], v9 offset:13312
    v_mfma_f32_32x32x16_bf16 v[16:31], v[84:87], v[208:211], v[16:31]
    ds_read_b64_tr_b16 a[192:193], v6 offset:16384
    ds_read_b64_tr_b16 a[194:195], v6 offset:17408
    ds_read_b64_tr_b16 a[196:197], v7 offset:16384
    ds_read_b64_tr_b16 a[198:199], v7 offset:17408
    v_mfma_f32_32x32x16_bf16 v[16:31], a[84:87], v[212:215], v[16:31]
    ds_read_b64_tr_b16 a[200:201], v8 offset:16384
    ds_read_b64_tr_b16 a[202:203], v8 offset:17408
    ds_read_b64_tr_b16 a[204:205], v9 offset:16384
    ds_read_b64_tr_b16 a[206:207], v9 offset:17408
    v_mfma_f32_32x32x16_bf16 v[16:31], a[88:91], v[216:219], v[16:31]
    buffer_load_dwordx4 v123, s[20:23], s3 offen offset:3072 lds
    s_add_u32 m0, m0, 4096
    ds_read_b64_tr_b16 a[208:209], v6 offset:20480
    v_mfma_f32_32x32x16_bf16 v[16:31], a[92:95], v[220:223], v[16:31]
    ds_read_b64_tr_b16 a[210:211], v6 offset:21504
    ds_read_b64_tr_b16 a[212:213], v7 offset:20480
    ds_read_b64_tr_b16 a[214:215], v7 offset:21504
    ds_read_b64_tr_b16 a[216:217], v8 offset:20480
    v_mfma_f32_32x32x16_bf16 v[16:31], v[88:91], v[224:227], v[16:31]
    ds_read_b64_tr_b16 a[218:219], v8 offset:21504
    ds_read_b64_tr_b16 a[220:221], v9 offset:20480
    ds_read_b64_tr_b16 a[222:223], v9 offset:21504
    ds_read_b64_tr_b16 a[224:225], v6 offset:24576
    v_mfma_f32_32x32x16_bf16 v[16:31], a[100:103], v[228:231], v[16:31]
    buffer_load_dwordx4 v124, s[20:23], s3 offen lds
    ds_read_b64_tr_b16 a[226:227], v6 offset:25600
    v_mfma_f32_32x32x16_bf16 v[16:31], a[104:107], v[232:235], v[16:31]
    ds_read_b64_tr_b16 a[228:229], v7 offset:24576
    ds_read_b64_tr_b16 a[230:231], v7 offset:25600
    ds_read_b64_tr_b16 a[232:233], v8 offset:24576
    ds_read_b64_tr_b16 a[234:235], v8 offset:25600
    v_mfma_f32_32x32x16_bf16 v[16:31], a[108:111], v[236:239], v[16:31]
    ds_read_b64_tr_b16 a[236:237], v9 offset:24576
    ds_read_b64_tr_b16 a[238:239], v9 offset:25600
    v_mfma_f32_32x32x16_bf16 v[16:31], v[92:95], v[240:243], v[16:31]
    buffer_load_dwordx4 v125, s[20:23], s3 offen offset:1024 lds
    v_mfma_f32_32x32x16_bf16 v[16:31], a[116:119], v[244:247], v[16:31]
    v_mfma_f32_32x32x16_bf16 v[16:31], a[120:123], v[248:251], v[16:31]
    v_mfma_f32_32x32x16_bf16 v[16:31], a[124:127], v[252:255], v[16:31]
    buffer_load_dwordx4 v126, s[20:23], s3 offen offset:2048 lds
    s_waitcnt lgkmcnt(15)
    s_nop 9
    v_fmac_f32 v16, v96, v48
    v_fmac_f32 v17, v96, v49
    v_fmac_f32 v18, v96, v50
    v_fmac_f32 v19, v96, v51
    v_fmac_f32 v20, v96, v52
    v_fmac_f32 v21, v96, v53
    v_fmac_f32 v22, v96, v54
    v_fmac_f32 v23, v96, v55
    v_fmac_f32 v24, v96, v56
    v_fmac_f32 v25, v96, v57
    v_fmac_f32 v26, v96, v58
    v_fmac_f32 v27, v96, v59
    v_fmac_f32 v28, v96, v60
    v_fmac_f32 v29, v96, v61
    v_fmac_f32 v30, v96, v62
    v_fmac_f32 v31, v96, v63
    v_cvt_pk_bf16_f32 v48, v16, v17
    v_cvt_pk_bf16_f32 v49, v18, v19
    v_cvt_pk_bf16_f32 v50, v20, v21
    v_cvt_pk_bf16_f32 v51, v22, v23
    v_cvt_pk_bf16_f32 v52, v24, v25
    v_cvt_pk_bf16_f32 v53, v26, v27
    v_cvt_pk_bf16_f32 v54, v28, v29
    v_cvt_pk_bf16_f32 v55, v30, v31
    v_mfma_f32_32x32x16_bf16 v[64:79], v[104:107], v[48:51], 0
    s_nop 0
    v_mfma_f32_32x32x16_bf16 v[80:95], v[108:111], v[52:55], 0
    v_accvgpr_read_b32 v10, a64
    v_accvgpr_read_b32 v11, a65
    v_accvgpr_read_b32 v12, a66
    v_accvgpr_read_b32 v13, a67
    v_accvgpr_read_b32 v2, a80
    v_accvgpr_read_b32 v4, a81
    v_accvgpr_read_b32 v5, a82
    s_mov_b32 s12, 0x3f80
    s_mov_b32 s13, 0x3f800000
    s_nop 0
    v_max3_f32 v16, v64, v65, v66
    s_nop 0
    v_max3_f32 v18, v80, v81, v82
    v_max3_f32 v16, v16, v67, v68
    v_max3_f32 v18, v18, v83, v84
    v_max3_f32 v16, v16, v69, v70
    v_max3_f32 v18, v18, v85, v86
    v_max3_f32 v16, v16, v71, v72
    v_max3_f32 v18, v18, v87, v88
    v_max3_f32 v16, v16, v73, v74
    v_max3_f32 v18, v18, v89, v90
    v_max3_f32 v16, v16, v75, v76
    v_max3_f32 v18, v18, v91, v92
    v_max3_f32 v16, v16, v77, v78
    v_max3_f32 v18, v18, v93, v94
    v_max_f32 v16, v16, v79
    v_max_f32 v18, v18, v95
    v_mul_f32 v16, v16, v101
    v_mul_f32 v18, v18, v101
    v_pk_fma_f32 v[64:65], v[64:65], v[100:101], v[16:17] op_sel_hi:[1,0,0]
    v_pk_fma_f32 v[66:67], v[66:67], v[100:101], v[16:17] op_sel_hi:[1,0,0]
    v_pk_fma_f32 v[68:69], v[68:69], v[100:101], v[16:17] op_sel_hi:[1,0,0]
    v_pk_fma_f32 v[70:71], v[70:71], v[100:101], v[16:17] op_sel_hi:[1,0,0]
    v_pk_fma_f32 v[72:73], v[72:73], v[100:101], v[16:17] op_sel_hi:[1,0,0]
    v_pk_fma_f32 v[74:75], v[74:75], v[100:101], v[16:17] op_sel_hi:[1,0,0]
    v_pk_fma_f32 v[76:77], v[76:77], v[100:101], v[16:17] op_sel_hi:[1,0,0]
    v_pk_fma_f32 v[78:79], v[78:79], v[100:101], v[16:17] op_sel_hi:[1,0,0]
    v_pk_fma_f32 v[80:81], v[80:81], v[100:101], v[18:19] op_sel_hi:[1,0,0]
    v_pk_fma_f32 v[82:83], v[82:83], v[100:101], v[18:19] op_sel_hi:[1,0,0]
    v_pk_fma_f32 v[84:85], v[84:85], v[100:101], v[18:19] op_sel_hi:[1,0,0]
    v_pk_fma_f32 v[86:87], v[86:87], v[100:101], v[18:19] op_sel_hi:[1,0,0]
    v_pk_fma_f32 v[88:89], v[88:89], v[100:101], v[18:19] op_sel_hi:[1,0,0]
    v_pk_fma_f32 v[90:91], v[90:91], v[100:101], v[18:19] op_sel_hi:[1,0,0]
    v_pk_fma_f32 v[92:93], v[92:93], v[100:101], v[18:19] op_sel_hi:[1,0,0]
    v_pk_fma_f32 v[94:95], v[94:95], v[100:101], v[18:19] op_sel_hi:[1,0,0]
    s_cmp_lg_u32 s48, 0
    s_cbranch_scc1 L_noep
    s_lshl_b32 s72, s49, 8
    s_mov_b64 exec, 1
    v_mov_b32 v127, 0
    buffer_atomic_add v127, off, s[32:35], s72 sc0 sc1
    s_mov_b64 exec, -1
L_noep:
    v_exp_f32 v64, v64
    v_exp_f32 v65, v65
    v_exp_f32 v66, v66
    v_exp_f32 v67, v67
    v_exp_f32 v68, v68
    v_exp_f32 v69, v69
    v_exp_f32 v70, v70
    v_exp_f32 v71, v71
    v_exp_f32 v72, v72
    v_exp_f32 v73, v73
    v_exp_f32 v74, v74
    v_exp_f32 v75, v75
    v_exp_f32 v76, v76
    v_exp_f32 v77, v77
    v_exp_f32 v78, v78
    v_exp_f32 v79, v79
    v_exp_f32 v80, v80
    v_exp_f32 v81, v81
    v_exp_f32 v82, v82
    v_exp_f32 v83, v83
    v_exp_f32 v84, v84
    v_exp_f32 v85, v85
    v_exp_f32 v86, v86
    v_exp_f32 v87, v87
    v_exp_f32 v88, v88
    v_exp_f32 v89, v89
    v_exp_f32 v90, v90
    v_exp_f32 v91, v91
    v_exp_f32 v92, v92
    v_exp_f32 v93, v93
    v_exp_f32 v94, v94
    v_exp_f32 v95, v95
    v_pk_add_f32 v[20:21], v[64:65], v[66:67]
    v_pk_add_f32 v[28:29], v[80:81], v[82:83]
    v_pk_add_f32 v[22:23], v[68:69], v[70:71]
    v_pk_add_f32 v[30:31], v[84:85], v[86:87]
    v_pk_add_f32 v[24:25], v[72:73], v[74:75]
    v_pk_add_f32 v[32:33], v[88:89], v[90:91]
    v_pk_add_f32 v[26:27], v[76:77], v[78:79]
    v_pk_add_f32 v[34:35], v[92:93], v[94:95]
    v_pk_add_f32 v[20:21], v[20:21], v[22:23]
    v_pk_add_f32 v[28:29], v[28:29], v[30:31]
    v_pk_add_f32 v[24:25], v[24:25], v[26:27]
    v_pk_add_f32 v[32:33], v[32:33], v[34:35]
    v_pk_add_f32 v[20:21], v[20:21], v[24:25]
    v_pk_add_f32 v[28:29], v[28:29], v[32:33]
    v_add_f32 v20, v20, v21
    v_add_f32 v28, v28, v29
    v_rcp_f32 v20, v20
    v_rcp_f32 v28, v28
    v_pk_mul_f32 v[64:65], v[64:65], v[20:21] op_sel_hi:[1,0]
    v_pk_mul_f32 v[66:67], v[66:67], v[20:21] op_sel_hi:[1,0]
    v_pk_mul_f32 v[68:69], v[68:69], v[20:21] op_sel_hi:[1,0]
    v_pk_mul_f32 v[70:71], v[70:71], v[20:21] op_sel_hi:[1,0]
    v_pk_mul_f32 v[72:73], v[72:73], v[20:21] op_sel_hi:[1,0]
    v_pk_mul_f32 v[74:75], v[74:75], v[20:21] op_sel_hi:[1,0]
    v_pk_mul_f32 v[76:77], v[76:77], v[20:21] op_sel_hi:[1,0]
    v_pk_mul_f32 v[78:79], v[78:79], v[20:21] op_sel_hi:[1,0]
    v_pk_mul_f32 v[80:81], v[80:81], v[28:29] op_sel_hi:[1,0]
    v_pk_mul_f32 v[82:83], v[82:83], v[28:29] op_sel_hi:[1,0]
    v_pk_mul_f32 v[84:85], v[84:85], v[28:29] op_sel_hi:[1,0]
    v_pk_mul_f32 v[86:87], v[86:87], v[28:29] op_sel_hi:[1,0]
    v_pk_mul_f32 v[88:89], v[88:89], v[28:29] op_sel_hi:[1,0]
    v_pk_mul_f32 v[90:91], v[90:91], v[28:29] op_sel_hi:[1,0]
    v_pk_mul_f32 v[92:93], v[92:93], v[28:29] op_sel_hi:[1,0]
    v_pk_mul_f32 v[94:95], v[94:95], v[28:29] op_sel_hi:[1,0]
    v_cvt_pk_bf16_f32 v32, v64, v65
    v_cvt_pk_bf16_f32 v33, v66, v67
    v_cvt_pk_bf16_f32 v34, v68, v69
    v_cvt_pk_bf16_f32 v35, v70, v71
    v_cvt_pk_bf16_f32 v36, v72, v73
    v_cvt_pk_bf16_f32 v37, v74, v75
    v_cvt_pk_bf16_f32 v38, v76, v77
    v_cvt_pk_bf16_f32 v39, v78, v79
    v_cvt_pk_bf16_f32 v40, v80, v81
    v_cvt_pk_bf16_f32 v41, v82, v83
    v_cvt_pk_bf16_f32 v42, v84, v85
    v_cvt_pk_bf16_f32 v43, v86, v87
    v_cvt_pk_bf16_f32 v44, v88, v89
    v_cvt_pk_bf16_f32 v45, v90, v91
    v_cvt_pk_bf16_f32 v46, v92, v93
    v_cvt_pk_bf16_f32 v47, v94, v95
    s_waitcnt lgkmcnt(0)
    s_cmp_lg_u32 s48, 0
    s_cbranch_scc1 L_poll_3_done
    s_lshl_b32 s72, s49, 8
    s_add_u32 s72, s72, 0
    s_mov_b64 exec, 1
    s_mov_b32 s74, 0
    s_waitcnt vmcnt(0)
    v_cmp_le_u32 vcc, 16, v127
    s_cbranch_vccnz L_poll_3_out
.p2align 6
L_poll_3:
    v_mov_b32 v127, 0
    buffer_atomic_add v127, off, s[32:35], s72 sc0 sc1
    s_add_u32 s74, s74, 1
    s_cmp_ge_u32 s74, 0x80000
    s_cbranch_scc1 L_poll_3_to
    s_waitcnt vmcnt(0)
    v_cmp_gt_u32 vcc, 16, v127
    s_cbranch_vccnz L_poll_3
L_poll_3_to:
    s_waitcnt vmcnt(0)
L_poll_3_out:
    s_mov_b64 exec, -1
L_poll_3_done:
    s_barrier
    buffer_load_dword v192, v4, s[32:35], 0 offen sc1
    buffer_load_dword v193, v4, s[32:35], 0 offen offset:512 sc1
    buffer_load_dword v194, v4, s[32:35], 0 offen offset:1024 sc1
    buffer_load_dword v195, v4, s[32:35], 0 offen offset:1536 sc1
    buffer_load_dwordx4 v[128:131], v2, s[32:35], 0 offen sc1
    buffer_load_dwordx4 v[132:135], v2, s[32:35], 0 offen offset:1024 sc1
    buffer_load_dwordx4 v[136:139], v2, s[32:35], 0 offen offset:2048 sc1
    buffer_load_dwordx4 v[140:143], v2, s[32:35], 0 offen offset:3072 sc1
    buffer_load_dwordx4 v[144:147], v2, s[32:35], s62 offen sc1
    buffer_load_dwordx4 v[148:151], v2, s[32:35], s62 offen offset:1024 sc1
    buffer_load_dwordx4 v[152:155], v2, s[32:35], s62 offen offset:2048 sc1
    buffer_load_dwordx4 v[156:159], v2, s[32:35], s62 offen offset:3072 sc1
    v_mov_b32 v160, 0
    v_mov_b32 v161, 0
    v_mov_b32 v162, 0
    v_mov_b32 v163, 0
    v_mov_b32 v164, 0
    v_mov_b32 v165, 0
    v_mov_b32 v166, 0
    v_mov_b32 v167, 0
    v_lshrrev_b32 v15, 2, v0
    v_mul_u32_u24 v15, 224, v15
    v_and_b32 v103, 3, v0
    v_lshl_add_u32 v15, v103, 3, v15
    s_mul_i32 s73, s48, 7168
    s_add_u32 s73, s73, 98304
    v_add_u32 v103, s73, v15
    v_add_u32 v15, s57, v15
    v_mov_b32 v104, 0
    v_mov_b32 v105, 0
    v_mov_b32 v106, 0
    v_mov_b32 v107, 0
    v_mov_b32 v108, 0
    v_mov_b32 v109, 0
    v_mov_b32 v110, 0
    v_mov_b32 v111, 0
    s_waitcnt vmcnt(12)
    ds_read_b64_tr_b16 v[72:73], v15
    ds_read_b64_tr_b16 v[74:75], v15 offset:3584
    ds_read_b64_tr_b16 v[76:77], v15 offset:32
    ds_read_b64_tr_b16 v[78:79], v15 offset:3616
    ds_read_b64_tr_b16 v[80:81], v15 offset:64
    ds_read_b64_tr_b16 v[82:83], v15 offset:3648
    ds_read_b64_tr_b16 v[84:85], v15 offset:96
    ds_read_b64_tr_b16 v[86:87], v15 offset:3680
    ds_read_b64_tr_b16 v[88:89], v15 offset:128
    ds_read_b64_tr_b16 v[90:91], v15 offset:3712
    ds_read_b64_tr_b16 v[92:93], v15 offset:160
    ds_read_b64_tr_b16 v[94:95], v15 offset:3744
    ds_read_b64_tr_b16 v[96:97], v15 offset:192
    ds_read_b64_tr_b16 v[98:99], v15 offset:3776
    s_waitcnt lgkmcnt(6)
    v_dot2c_f32_bf16 v104, s70, v72
    v_dot2c_f32_bf16 v105, s70, v76
    v_dot2c_f32_bf16 v106, s70, v80
    v_dot2c_f32_bf16 v107, s70, v84
    v_dot2c_f32_bf16 v104, s70, v73
    v_dot2c_f32_bf16 v105, s70, v77
    v_dot2c_f32_bf16 v106, s70, v81
    v_dot2c_f32_bf16 v107, s70, v85
    v_dot2c_f32_bf16 v104, s70, v74
    v_dot2c_f32_bf16 v105, s70, v78
    v_dot2c_f32_bf16 v106, s70, v82
    v_dot2c_f32_bf16 v107, s70, v86
    v_dot2c_f32_bf16 v104, s70, v75
    v_dot2c_f32_bf16 v105, s70, v79
    v_dot2c_f32_bf16 v106, s70, v83
    v_dot2c_f32_bf16 v107, s70, v87
    s_waitcnt lgkmcnt(0)
    v_dot2c_f32_bf16 v108, s70, v88
    v_dot2c_f32_bf16 v109, s70, v92
    v_dot2c_f32_bf16 v110, s70, v96
    v_dot2c_f32_bf16 v108, s70, v89
    v_dot2c_f32_bf16 v109, s70, v93
    v_dot2c_f32_bf16 v110, s70, v97
    v_dot2c_f32_bf16 v108, s70, v90
    v_dot2c_f32_bf16 v109, s70, v94
    v_dot2c_f32_bf16 v110, s70, v98
    v_dot2c_f32_bf16 v108, s70, v91
    v_dot2c_f32_bf16 v109, s70, v95
    v_dot2c_f32_bf16 v110, s70, v99
    s_waitcnt vmcnt(8)
    v_add_f32 v192, v192, v193
    v_add_f32 v194, v194, v195
    v_add_f32 v192, v192, v194
    v_mov_b32 v193, v192
    s_add_u32 m0, s57, 7168
    s_add_u32 s3, s48, 4
    s_mul_i32 s3, s3, 114688
    buffer_load_dwordx4 v120, s[20:23], s3 offen lds
    v_permlane32_swap_b32 v192, v193
    v_add_f32 v192, v192, v193
    v_mov_b32 v193, v192
    buffer_load_dwordx4 v121, s[20:23], s3 offen offset:1024 lds
    s_nop 0
    v_permlane16_swap_b32 v192, v193
    v_add_f32 v192, v192, v193
    v_cvt_pk_bf16_f32 v192, v192, v192
    ds_write_b16 v11, v192 offset:1024
    s_waitcnt vmcnt(9)
    v_dot2c_f32_bf16 v160, s12, v128
    v_dot2c_f32_bf16 v161, s13, v128
    v_dot2c_f32_bf16 v162, s12, v129
    v_dot2c_f32_bf16 v163, s13, v129
    v_dot2c_f32_bf16 v164, s12, v130
    v_dot2c_f32_bf16 v165, s13, v130
    v_dot2c_f32_bf16 v166, s12, v131
    v_dot2c_f32_bf16 v167, s13, v131
    s_waitcnt vmcnt(8)
    v_dot2c_f32_bf16 v160, s12, v132
    v_dot2c_f32_bf16 v161, s13, v132
    v_dot2c_f32_bf16 v162, s12, v133
    v_dot2c_f32_bf16 v163, s13, v133
    v_dot2c_f32_bf16 v164, s12, v134
    v_dot2c_f32_bf16 v165, s13, v134
    v_dot2c_f32_bf16 v166, s12, v135
    v_dot2c_f32_bf16 v167, s13, v135
    s_waitcnt vmcnt(7)
    v_dot2c_f32_bf16 v160, s12, v136
    v_dot2c_f32_bf16 v161, s13, v136
    v_dot2c_f32_bf16 v162, s12, v137
    v_dot2c_f32_bf16 v163, s13, v137
    v_dot2c_f32_bf16 v164, s12, v138
    v_dot2c_f32_bf16 v165, s13, v138
    v_dot2c_f32_bf16 v166, s12, v139
    v_dot2c_f32_bf16 v167, s13, v139
    s_waitcnt vmcnt(6)
    v_dot2c_f32_bf16 v160, s12, v140
    v_dot2c_f32_bf16 v161, s13, v140
    v_dot2c_f32_bf16 v162, s12, v141
    v_dot2c_f32_bf16 v163, s13, v141
    v_dot2c_f32_bf16 v164, s12, v142
    v_dot2c_f32_bf16 v165, s13, v142
    v_dot2c_f32_bf16 v166, s12, v143
    v_dot2c_f32_bf16 v167, s13, v143
    s_waitcnt vmcnt(5)
    v_dot2c_f32_bf16 v160, s12, v144
    v_dot2c_f32_bf16 v161, s13, v144
    v_dot2c_f32_bf16 v162, s12, v145
    v_dot2c_f32_bf16 v163, s13, v145
    v_dot2c_f32_bf16 v164, s12, v146
    v_dot2c_f32_bf16 v165, s13, v146
    v_dot2c_f32_bf16 v166, s12, v147
    v_dot2c_f32_bf16 v167, s13, v147
    s_waitcnt vmcnt(4)
    v_dot2c_f32_bf16 v160, s12, v148
    v_dot2c_f32_bf16 v161, s13, v148
    v_dot2c_f32_bf16 v162, s12, v149
    v_dot2c_f32_bf16 v163, s13, v149
    v_dot2c_f32_bf16 v164, s12, v150
    v_dot2c_f32_bf16 v165, s13, v150
    v_dot2c_f32_bf16 v166, s12, v151
    v_dot2c_f32_bf16 v167, s13, v151
    s_waitcnt vmcnt(3)
    v_dot2c_f32_bf16 v160, s12, v152
    v_dot2c_f32_bf16 v161, s13, v152
    v_dot2c_f32_bf16 v162, s12, v153
    v_dot2c_f32_bf16 v163, s13, v153
    v_dot2c_f32_bf16 v164, s12, v154
    v_dot2c_f32_bf16 v165, s13, v154
    v_dot2c_f32_bf16 v166, s12, v155
    v_dot2c_f32_bf16 v167, s13, v155
    s_waitcnt vmcnt(2)
    v_dot2c_f32_bf16 v160, s12, v156
    v_dot2c_f32_bf16 v161, s13, v156
    v_dot2c_f32_bf16 v162, s12, v157
    v_dot2c_f32_bf16 v163, s13, v157
    v_dot2c_f32_bf16 v164, s12, v158
    v_dot2c_f32_bf16 v165, s13, v158
    v_dot2c_f32_bf16 v166, s12, v159
    v_dot2c_f32_bf16 v167, s13, v159
    v_permlane32_swap_b32 v160, v164
    v_permlane32_swap_b32 v161, v165
    v_permlane32_swap_b32 v162, v166
    v_permlane32_swap_b32 v163, v167
    v_pk_add_f32 v[160:161], v[160:161], v[164:165]
    v_pk_add_f32 v[162:163], v[162:163], v[166:167]
    v_cvt_pk_bf16_f32 v128, v160, v161
    v_cvt_pk_bf16_f32 v129, v162, v163
    ds_write_b64 v10, v[128:129]
    s_waitcnt lgkmcnt(0)
    s_barrier
    ds_read_b128 v[64:67], v12
    ds_read_b128 v[68:71], v12 offset:16
    ds_read_b128 v[72:75], v12 offset:1088
    ds_read_b128 v[76:79], v12 offset:1104
    buffer_load_dwordx4 v122, s[20:23], s3 offen offset:2048 lds
    buffer_load_dwordx4 v123, s[20:23], s3 offen offset:3072 lds
    s_add_u32 m0, m0, 4096
    s_nop 0
    buffer_load_dwordx4 v124, s[20:23], s3 offen lds
    buffer_load_dwordx4 v125, s[20:23], s3 offen offset:1024 lds
    buffer_load_dwordx4 v126, s[20:23], s3 offen offset:2048 lds
    s_waitcnt lgkmcnt(2)
    v_mfma_f32_32x32x16_bf16 v[80:95], v[64:67], v[32:35], 0
    v_mfma_f32_32x32x16_bf16 v[80:95], v[68:71], v[36:39], v[80:95]
    s_waitcnt lgkmcnt(0)
    v_mfma_f32_32x32x16_bf16 v[208:223], v[72:75], v[40:43], 0
    v_mfma_f32_32x32x16_bf16 v[208:223], v[76:79], v[44:47], v[208:223]
    s_lshl_b32 s56, s51, 1
    s_add_u32 s56, s56, s53
    s_lshl_b32 s56, s56, 2
    s_add_u32 s56, s56, s48
    s_lshl_b32 s75, s56, 14
    s_lshl_b32 s73, s54, 7
    s_add_u32 s59, s75, s73
    s_nop 1
    v_add_f32 v88, 0x358637bd, v88
    v_rcp_f32 v88, v88
    s_nop 0
    v_mul_f32 v80, v80, v88
    v_mul_f32 v81, v81, v88
    v_mul_f32 v82, v82, v88
    v_mul_f32 v83, v83, v88
    v_mul_f32 v84, v84, v88
    v_mul_f32 v85, v85, v88
    v_mul_f32 v86, v86, v88
    v_mul_f32 v87, v87, v88
    v_cvt_pk_bf16_f32 v112, v80, v81
    v_cvt_pk_bf16_f32 v113, v82, v83
    v_cvt_pk_bf16_f32 v114, v84, v85
    v_cvt_pk_bf16_f32 v115, v86, v87
    buffer_store_dwordx4 v[112:115], v13, s[32:35], 0 offen sc1
    v_add_f32 v216, 0x358637bd, v216
    v_rcp_f32 v216, v216
    s_nop 0
    v_pk_mul_f32 v[208:209], v[208:209], v[216:217] op_sel_hi:[1,0]
    v_pk_mul_f32 v[210:211], v[210:211], v[216:217] op_sel_hi:[1,0]
    v_pk_mul_f32 v[212:213], v[212:213], v[216:217] op_sel_hi:[1,0]
    v_pk_mul_f32 v[214:215], v[214:215], v[216:217] op_sel_hi:[1,0]
    v_cvt_pk_bf16_f32 v116, v208, v209
    v_cvt_pk_bf16_f32 v117, v210, v211
    v_cvt_pk_bf16_f32 v118, v212, v213
    v_cvt_pk_bf16_f32 v119, v214, v215
    buffer_store_dwordx4 v[116:119], v13, s[32:35], 0 offen offset:512 sc1
    v_lshrrev_b32 v10, 4, v0
    v_lshlrev_b32 v10, 3, v10
    v_and_b32 v14, 15, v0
    v_lshl_add_u32 v14, v14, 10, v10
    v_lshlrev_b32 v11, 2, v0
    v_and_b32 v14, 15, v0
    v_lshlrev_b32 v14, 10, v14
    v_bfe_u32 v12, v0, 4, 1
    v_lshl_add_u32 v14, v12, 5, v14
    v_lshrrev_b32 v12, 5, v0
    v_lshl_add_u32 v14, v12, 4, v14
    v_add_u32 v10, 91392, v10
    v_add_u32 v11, 91136, v11
    ds_read_b32 v32, v11
    ds_read_b64 v[56:57], v10
    ds_read_b64 v[58:59], v10 offset:32
    ds_read_b64 v[60:61], v10 offset:64
    ds_read_b64 v[62:63], v10 offset:96
    s_and_b32 s75, s56, 31
    s_lshl_b32 s75, s75, 14
    s_lshr_b32 s74, s56, 5
    s_lshl_b32 s74, s74, 21
    s_add_u32 s75, s75, s74
    s_add_u32 s74, s75, 4194304
    v_add_u32 v2, s74, v1
    s_lshl_b32 s74, s54, 11
    s_add_u32 s74, s74, s75
    s_add_u32 s74, s74, 4718592
    v_add_u32 v3, s74, v1
    s_lshl_b32 s74, s56, 10
    s_add_u32 s74, s74, s73
    s_add_u32 s74, s74, 1179648
    v_lshlrev_b32 v4, 3, v0
    v_add_u32 v4, s74, v4
    s_lshl_b32 s72, s50, 8
    s_add_u32 s72, s72, 4096
    v_mov_b32 v127, 1
    s_cmp_lg_u32 s48, 0
    s_waitcnt vmcnt(0)
    s_barrier
    s_cbranch_scc1 L_arr_4
    s_mov_b64 exec, 1
    buffer_atomic_add v127, off, s[32:35], s72 sc1
    s_mov_b64 exec, -1
L_arr_4:
    buffer_load_dwordx4 v[48:51], v14, s[4:7], s59 offen
    buffer_load_dwordx4 v[52:55], v14, s[4:7], s59 offen offset:64
    s_add_u32 m0, s57, 14336
    s_add_u32 s3, s48, 8
    s_mul_i32 s3, s3, 114688
    buffer_load_dwordx4 v120, s[20:23], s3 offen lds
    buffer_load_dwordx4 v121, s[20:23], s3 offen offset:1024 lds
    buffer_load_dwordx4 v122, s[20:23], s3 offen offset:2048 lds
    buffer_load_dwordx4 v123, s[20:23], s3 offen offset:3072 lds
    s_add_u32 m0, m0, 4096
    s_nop 0
    buffer_load_dwordx4 v124, s[20:23], s3 offen lds
    buffer_load_dwordx4 v125, s[20:23], s3 offen offset:1024 lds
    buffer_load_dwordx4 v126, s[20:23], s3 offen offset:2048 lds
    ds_read_b64_tr_b16 v[80:81], v6 offset:28672
    ds_read_b64_tr_b16 v[82:83], v6 offset:29696
    ds_read_b64_tr_b16 v[84:85], v7 offset:28672
    ds_read_b64_tr_b16 v[86:87], v7 offset:29696
    ds_read_b64_tr_b16 v[88:89], v8 offset:28672
    ds_read_b64_tr_b16 v[90:91], v8 offset:29696
    ds_read_b64_tr_b16 v[92:93], v9 offset:28672
    ds_read_b64_tr_b16 v[94:95], v9 offset:29696
    ds_read_b64_tr_b16 v[192:193], v6 offset:32768
    ds_read_b64_tr_b16 v[194:195], v6 offset:33792
    ds_read_b64_tr_b16 v[196:197], v7 offset:32768
    ds_read_b64_tr_b16 v[198:199], v7 offset:33792
    ds_read_b64_tr_b16 v[200:201], v8 offset:32768
    ds_read_b64_tr_b16 v[202:203], v8 offset:33792
    ds_read_b64_tr_b16 v[204:205], v9 offset:32768
    ds_read_b64_tr_b16 v[206:207], v9 offset:33792
    ds_read_b64_tr_b16 v[208:209], v6 offset:36864
    ds_read_b64_tr_b16 v[210:211], v6 offset:37888
    ds_read_b64_tr_b16 v[212:213], v7 offset:36864
    ds_read_b64_tr_b16 v[214:215], v7 offset:37888
    ds_read_b64_tr_b16 v[216:217], v8 offset:36864
    ds_read_b64_tr_b16 v[218:219], v8 offset:37888
    ds_read_b64_tr_b16 v[220:221], v9 offset:36864
    ds_read_b64_tr_b16 v[222:223], v9 offset:37888
    ds_read_b64_tr_b16 v[224:225], v6 offset:40960
    ds_read_b64_tr_b16 v[226:227], v6 offset:41984
    ds_read_b64_tr_b16 v[228:229], v7 offset:40960
    ds_read_b64_tr_b16 v[230:231], v7 offset:41984
    ds_read_b64_tr_b16 v[232:233], v8 offset:40960
    ds_read_b64_tr_b16 v[234:235], v8 offset:41984
    ds_read_b64_tr_b16 v[236:237], v9 offset:40960
    ds_read_b64_tr_b16 v[238:239], v9 offset:41984
    ds_read_b64_tr_b16 v[240:241], v6 offset:45056
    ds_read_b64_tr_b16 v[242:243], v6 offset:46080
    ds_read_b64_tr_b16 v[244:245], v7 offset:45056
    ds_read_b64_tr_b16 v[246:247], v7 offset:46080
    ds_read_b64_tr_b16 v[248:249], v8 offset:45056
    ds_read_b64_tr_b16 v[250:251], v8 offset:46080
    ds_read_b64_tr_b16 v[252:253], v9 offset:45056
    ds_read_b64_tr_b16 v[254:255], v9 offset:46080
    ds_read_b64_tr_b16 v[64:65], v6 offset:49152
    ds_read_b64_tr_b16 v[66:67], v6 offset:50176
    ds_read_b64_tr_b16 v[68:69], v7 offset:49152
    ds_read_b64_tr_b16 v[70:71], v7 offset:50176
    ds_read_b64_tr_b16 v[72:73], v8 offset:49152
    ds_read_b64_tr_b16 v[74:75], v8 offset:50176
    ds_read_b64_tr_b16 v[76:77], v9 offset:49152
    ds_read_b64_tr_b16 v[78:79], v9 offset:50176
    s_waitcnt vmcnt(7) lgkmcnt(15)
    v_lshlrev_b32 v34, 16, v32
    v_and_b32 v35, 0xffff0000, v32
    v_lshlrev_b32 v11, 3, v0
    v_add_u32 v11, 97280, v11
    ds_write_b64 v11, v[34:35]
    v_permlane16_swap_b32 v48, v50
    v_permlane16_swap_b32 v49, v51
    v_permlane16_swap_b32 v52, v54
    v_permlane16_swap_b32 v53, v55
    v_lshlrev_b32 v16, 16, v48
    v_and_b32 v17, 0xffff0000, v48
    v_lshlrev_b32 v18, 16, v49
    v_and_b32 v19, 0xffff0000, v49
    v_lshlrev_b32 v20, 16, v50
    v_and_b32 v21, 0xffff0000, v50
    v_lshlrev_b32 v22, 16, v51
    v_and_b32 v23, 0xffff0000, v51
    v_lshlrev_b32 v24, 16, v52
    v_and_b32 v25, 0xffff0000, v52
    v_lshlrev_b32 v26, 16, v53
    v_and_b32 v27, 0xffff0000, v53
    v_lshlrev_b32 v28, 16, v54
    v_and_b32 v29, 0xffff0000, v54
    v_lshlrev_b32 v30, 16, v55
    v_and_b32 v31, 0xffff0000, v55
    s_cmp_lg_u32 s48, 0
    s_cbranch_scc1 L_poll_5_done
    s_lshl_b32 s72, s51, 8
    s_add_u32 s72, s72, 4096
    s_mov_b64 exec, 1
    s_mov_b32 s74, 0
.p2align 6
L_poll_5:
    v_mov_b32 v127, 0
    buffer_atomic_add v127, off, s[32:35], s72 sc0 sc1
    s_add_u32 s74, s74, 1
    s_cmp_ge_u32 s74, 0x80000
    s_cbranch_scc1 L_poll_5_to
    s_waitcnt vmcnt(0)
    v_cmp_gt_u32 vcc, 16, v127
    s_cbranch_vccnz L_poll_5
L_poll_5_to:
    s_waitcnt vmcnt(0)
L_poll_5_out:
    s_mov_b64 exec, -1
L_poll_5_done:
    s_barrier
    buffer_load_dwordx4 v[128:131], v2, s[32:35], 0 offen sc1
    buffer_load_dwordx4 v[132:135], v2, s[32:35], 0 offen offset:1024 sc1
    buffer_load_dwordx4 v[136:139], v2, s[32:35], 0 offen offset:2048 sc1
    buffer_load_dwordx4 v[140:143], v2, s[32:35], 0 offen offset:3072 sc1
    buffer_load_dwordx4 v[144:147], v2, s[32:35], s62 offen sc1
    buffer_load_dwordx4 v[148:151], v2, s[32:35], s62 offen offset:1024 sc1
    buffer_load_dwordx4 v[152:155], v2, s[32:35], s62 offen offset:2048 sc1
    buffer_load_dwordx4 v[156:159], v2, s[32:35], s62 offen offset:3072 sc1
    buffer_load_dwordx4 v[160:163], v2, s[32:35], s63 offen sc1
    buffer_load_dwordx4 v[164:167], v2, s[32:35], s63 offen offset:1024 sc1
    ds_read_b64_tr_b16 v[32:33], v15 offset:7168
    ds_read_b64_tr_b16 v[34:35], v15 offset:10752
    ds_read_b64_tr_b16 v[36:37], v15 offset:7200
    ds_read_b64_tr_b16 v[38:39], v15 offset:10784
    ds_read_b64_tr_b16 v[40:41], v15 offset:7232
    ds_read_b64_tr_b16 v[42:43], v15 offset:10816
    ds_read_b64_tr_b16 v[44:45], v15 offset:7264
    ds_read_b64_tr_b16 v[46:47], v15 offset:10848
    ds_read_b64_tr_b16 v[48:49], v15 offset:7296
    ds_read_b64_tr_b16 v[50:51], v15 offset:10880
    ds_read_b64_tr_b16 v[52:53], v15 offset:7328
    ds_read_b64_tr_b16 v[54:55], v15 offset:10912
    ds_read_b64_tr_b16 v[96:97], v15 offset:7360
    ds_read_b64_tr_b16 v[98:99], v15 offset:10944
    s_waitcnt lgkmcnt(6)
    v_dot2c_f32_bf16 v104, s70, v32
    v_dot2c_f32_bf16 v105, s70, v36
    v_dot2c_f32_bf16 v106, s70, v40
    v_dot2c_f32_bf16 v107, s70, v44
    v_dot2c_f32_bf16 v104, s70, v33
    v_dot2c_f32_bf16 v105, s70, v37
    v_dot2c_f32_bf16 v106, s70, v41
    v_dot2c_f32_bf16 v107, s70, v45
    v_dot2c_f32_bf16 v104, s70, v34
    v_dot2c_f32_bf16 v105, s70, v38
    v_dot2c_f32_bf16 v106, s70, v42
    v_dot2c_f32_bf16 v107, s70, v46
    v_dot2c_f32_bf16 v104, s70, v35
    v_dot2c_f32_bf16 v105, s70, v39
    v_dot2c_f32_bf16 v106, s70, v43
    v_dot2c_f32_bf16 v107, s70, v47
    s_waitcnt lgkmcnt(0)
    v_dot2c_f32_bf16 v108, s70, v48
    v_dot2c_f32_bf16 v109, s70, v52
    v_dot2c_f32_bf16 v110, s70, v96
    v_dot2c_f32_bf16 v108, s70, v49
    v_dot2c_f32_bf16 v109, s70, v53
    v_dot2c_f32_bf16 v110, s70, v97
    v_dot2c_f32_bf16 v108, s70, v50
    v_dot2c_f32_bf16 v109, s70, v54
    v_dot2c_f32_bf16 v110, s70, v98
    v_dot2c_f32_bf16 v108, s70, v51
    v_dot2c_f32_bf16 v109, s70, v55
    v_dot2c_f32_bf16 v110, s70, v99
    s_waitcnt vmcnt(10)
    ds_read_b64_tr_b16 v[32:33], v15 offset:14336
    ds_read_b64_tr_b16 v[34:35], v15 offset:17920
    ds_read_b64_tr_b16 v[36:37], v15 offset:14368
    ds_read_b64_tr_b16 v[38:39], v15 offset:17952
    ds_read_b64_tr_b16 v[40:41], v15 offset:14400
    ds_read_b64_tr_b16 v[42:43], v15 offset:17984
    ds_read_b64_tr_b16 v[44:45], v15 offset:14432
    ds_read_b64_tr_b16 v[46:47], v15 offset:18016
    ds_read_b64_tr_b16 v[48:49], v15 offset:14464
    ds_read_b64_tr_b16 v[50:51], v15 offset:18048
    ds_read_b64_tr_b16 v[52:53], v15 offset:14496
    ds_read_b64_tr_b16 v[54:55], v15 offset:18080
    ds_read_b64_tr_b16 v[96:97], v15 offset:14528
    ds_read_b64_tr_b16 v[98:99], v15 offset:18112
    s_waitcnt lgkmcnt(6)
    v_dot2c_f32_bf16 v104, s70, v32
    v_dot2c_f32_bf16 v105, s70, v36
    v_dot2c_f32_bf16 v106, s70, v40
    v_dot2c_f32_bf16 v107, s70, v44
    v_dot2c_f32_bf16 v104, s70, v33
    v_dot2c_f32_bf16 v105, s70, v37
    v_dot2c_f32_bf16 v106, s70, v41
    v_dot2c_f32_bf16 v107, s70, v45
    v_dot2c_f32_bf16 v104, s70, v34
    v_dot2c_f32_bf16 v105, s70, v38
    v_dot2c_f32_bf16 v106, s70, v42
    v_dot2c_f32_bf16 v107, s70, v46
    v_dot2c_f32_bf16 v104, s70, v35
    v_dot2c_f32_bf16 v105, s70, v39
    v_dot2c_f32_bf16 v106, s70, v43
    v_dot2c_f32_bf16 v107, s70, v47
    s_waitcnt lgkmcnt(0)
    v_dot2c_f32_bf16 v108, s70, v48
    v_dot2c_f32_bf16 v109, s70, v52
    v_dot2c_f32_bf16 v110, s70, v96
    v_dot2c_f32_bf16 v108, s70, v49
    v_dot2c_f32_bf16 v109, s70, v53
    v_dot2c_f32_bf16 v110, s70, v97
    v_dot2c_f32_bf16 v108, s70, v50
    v_dot2c_f32_bf16 v109, s70, v54
    v_dot2c_f32_bf16 v110, s70, v98
    v_dot2c_f32_bf16 v108, s70, v51
    v_dot2c_f32_bf16 v109, s70, v55
    v_dot2c_f32_bf16 v110, s70, v99
    v_mov_b32 v32, 0
    v_mov_b32 v33, 0
    s_waitcnt vmcnt(9)
    v_mfma_f32_16x16x32_bf16 v[16:19], a[128:131], v[128:131], v[16:19]
    v_mfma_f32_16x16x32_bf16 v[20:23], a[132:135], v[128:131], v[20:23]
    buffer_load_dwordx4 v[168:171], v2, s[32:35], s63 offen offset:2048 sc1
    v_mfma_f32_16x16x32_bf16 v[24:27], a[136:139], v[128:131], v[24:27]
    v_mfma_f32_16x16x32_bf16 v[28:31], a[140:143], v[128:131], v[28:31]
    s_waitcnt vmcnt(9)
    v_mfma_f32_16x16x32_bf16 v[16:19], a[144:147], v[132:135], v[16:19]
    v_mfma_f32_16x16x32_bf16 v[20:23], a[148:151], v[132:135], v[20:23]
    buffer_load_dwordx4 v[172:175], v2, s[32:35], s63 offen offset:3072 sc1
    v_mfma_f32_16x16x32_bf16 v[24:27], a[152:155], v[132:135], v[24:27]
    v_mfma_f32_16x16x32_bf16 v[28:31], a[156:159], v[132:135], v[28:31]
    s_waitcnt vmcnt(9)
    v_mfma_f32_16x16x32_bf16 v[16:19], a[160:163], v[136:139], v[16:19]
    v_mfma_f32_16x16x32_bf16 v[20:23], a[164:167], v[136:139], v[20:23]
    buffer_load_dwordx4 v[176:179], v2, s[32:35], s64 offen sc1
    v_mfma_f32_16x16x32_bf16 v[24:27], a[168:171], v[136:139], v[24:27]
    v_mfma_f32_16x16x32_bf16 v[28:31], a[172:175], v[136:139], v[28:31]
    s_waitcnt vmcnt(9)
    v_mfma_f32_16x16x32_bf16 v[16:19], a[176:179], v[140:143], v[16:19]
    v_mfma_f32_16x16x32_bf16 v[20:23], a[180:183], v[140:143], v[20:23]
    buffer_load_dwordx4 v[180:183], v2, s[32:35], s64 offen offset:1024 sc1
    v_mfma_f32_16x16x32_bf16 v[24:27], a[184:187], v[140:143], v[24:27]
    v_mfma_f32_16x16x32_bf16 v[28:31], a[188:191], v[140:143], v[28:31]
    s_waitcnt vmcnt(9)
    v_mfma_f32_16x16x32_bf16 v[16:19], a[192:195], v[144:147], v[16:19]
    v_mfma_f32_16x16x32_bf16 v[20:23], a[196:199], v[144:147], v[20:23]
    buffer_load_dwordx4 v[184:187], v2, s[32:35], s64 offen offset:2048 sc1
    v_mfma_f32_16x16x32_bf16 v[24:27], a[200:203], v[144:147], v[24:27]
    v_mfma_f32_16x16x32_bf16 v[28:31], a[204:207], v[144:147], v[28:31]
    s_waitcnt vmcnt(9)
    v_mfma_f32_16x16x32_bf16 v[16:19], a[208:211], v[148:151], v[16:19]
    v_mfma_f32_16x16x32_bf16 v[20:23], a[212:215], v[148:151], v[20:23]
    buffer_load_dwordx4 v[188:191], v2, s[32:35], s64 offen offset:3072 sc1
    v_mfma_f32_16x16x32_bf16 v[24:27], a[216:219], v[148:151], v[24:27]
    v_mfma_f32_16x16x32_bf16 v[28:31], a[220:223], v[148:151], v[28:31]
    s_waitcnt vmcnt(9)
    v_mfma_f32_16x16x32_bf16 v[16:19], a[224:227], v[152:155], v[16:19]
    v_mfma_f32_16x16x32_bf16 v[20:23], a[228:231], v[152:155], v[20:23]
    s_mul_i32 s71, s48, 7168
    s_add_u32 m0, s71, 98304
    s_add_u32 s3, s48, 12
    s_mul_i32 s3, s3, 114688
    buffer_load_dwordx4 v120, s[20:23], s3 offen lds
    v_mfma_f32_16x16x32_bf16 v[24:27], a[232:235], v[152:155], v[24:27]
    buffer_load_dwordx4 v121, s[20:23], s3 offen offset:1024 lds
    v_mfma_f32_16x16x32_bf16 v[28:31], a[236:239], v[152:155], v[28:31]
    s_waitcnt vmcnt(10)
    v_mfma_f32_16x16x32_bf16 v[16:19], v[80:83], v[156:159], v[16:19]
    v_mfma_f32_16x16x32_bf16 v[20:23], v[84:87], v[156:159], v[20:23]
    ds_read_b64_tr_b16 v[80:81], v6 offset:53248
    ds_read_b64_tr_b16 v[82:83], v6 offset:54272
    v_mfma_f32_16x16x32_bf16 v[24:27], v[88:91], v[156:159], v[24:27]
    ds_read_b64_tr_b16 v[84:85], v7 offset:53248
    ds_read_b64_tr_b16 v[86:87], v7 offset:54272
    v_mfma_f32_16x16x32_bf16 v[28:31], v[92:95], v[156:159], v[28:31]
    ds_read_b64_tr_b16 v[88:89], v8 offset:53248
    ds_read_b64_tr_b16 v[90:91], v8 offset:54272
    s_waitcnt vmcnt(9)
    v_mfma_f32_16x16x32_bf16 v[16:19], v[192:195], v[160:163], v[16:19]
    ds_read_b64_tr_b16 v[92:93], v9 offset:53248
    ds_read_b64_tr_b16 v[94:95], v9 offset:54272
    v_mfma_f32_16x16x32_bf16 v[20:23], v[196:199], v[160:163], v[20:23]
    ds_read_b64_tr_b16 v[192:193], v6 offset:57344
    ds_read_b64_tr_b16 v[194:195], v6 offset:58368
    v_mfma_f32_16x16x32_bf16 v[24:27], v[200:203], v[160:163], v[24:27]
    ds_read_b64_tr_b16 v[196:197], v7 offset:57344
    ds_read_b64_tr_b16 v[198:199], v7 offset:58368
    v_mfma_f32_16x16x32_bf16 v[28:31], v[204:207], v[160:163], v[28:31]
    ds_read_b64_tr_b16 v[200:201], v8 offset:57344
    ds_read_b64_tr_b16 v[202:203], v8 offset:58368
    s_waitcnt vmcnt(8)
    v_mfma_f32_16x16x32_bf16 v[16:19], v[208:211], v[164:167], v[16:19]
    ds_read_b64_tr_b16 v[204:205], v9 offset:57344
    ds_read_b64_tr_b16 v[206:207], v9 offset:58368
    v_mfma_f32_16x16x32_bf16 v[20:23], v[212:215], v[164:167], v[20:23]
    ds_read_b64_tr_b16 v[208:209], v6 offset:61440
    ds_read_b64_tr_b16 v[210:211], v6 offset:62464
    v_mfma_f32_16x16x32_bf16 v[24:27], v[216:219], v[164:167], v[24:27]
    ds_read_b64_tr_b16 v[212:213], v7 offset:61440
    ds_read_b64_tr_b16 v[214:215], v7 offset:62464
    v_mfma_f32_16x16x32_bf16 v[28:31], v[220:223], v[164:167], v[28:31]
    ds_read_b64_tr_b16 v[216:217], v8 offset:61440
    ds_read_b64_tr_b16 v[218:219], v8 offset:62464
    s_waitcnt vmcnt(7)
    v_mfma_f32_16x16x32_bf16 v[16:19], v[224:227], v[168:171], v[16:19]
    ds_read_b64_tr_b16 v[220:221], v9 offset:61440
    ds_read_b64_tr_b16 v[222:223], v9 offset:62464
    v_mfma_f32_16x16x32_bf16 v[20:23], v[228:231], v[168:171], v[20:23]
    buffer_load_dwordx4 v122, s[20:23], s3 offen offset:2048 lds
    v_mfma_f32_16x16x32_bf16 v[24:27], v[232:235], v[168:171], v[24:27]
    buffer_load_dwordx4 v123, s[20:23], s3 offen offset:3072 lds
    s_add_u32 m0, m0, 4096
    v_mfma_f32_16x16x32_bf16 v[28:31], v[236:239], v[168:171], v[28:31]
    s_waitcnt vmcnt(8)
    v_mfma_f32_16x16x32_bf16 v[16:19], v[240:243], v[172:175], v[16:19]
    v_mfma_f32_16x16x32_bf16 v[20:23], v[244:247], v[172:175], v[20:23]
    buffer_load_dwordx4 v124, s[20:23], s3 offen lds
    v_mfma_f32_16x16x32_bf16 v[24:27], v[248:251], v[172:175], v[24:27]
    buffer_load_dwordx4 v125, s[20:23], s3 offen offset:1024 lds
    v_mfma_f32_16x16x32_bf16 v[28:31], v[252:255], v[172:175], v[28:31]
    s_waitcnt vmcnt(9)
    v_mfma_f32_16x16x32_bf16 v[16:19], v[64:67], v[176:179], v[16:19]
    v_mfma_f32_16x16x32_bf16 v[20:23], v[68:71], v[176:179], v[20:23]
    buffer_load_dwordx4 v126, s[20:23], s3 offen offset:2048 lds
    v_mfma_f32_16x16x32_bf16 v[24:27], v[72:75], v[176:179], v[24:27]
    v_mfma_f32_16x16x32_bf16 v[28:31], v[76:79], v[176:179], v[28:31]
    s_waitcnt vmcnt(9) lgkmcnt(15)
    v_mfma_f32_16x16x32_bf16 v[16:19], v[80:83], v[180:183], v[16:19]
    v_mfma_f32_16x16x32_bf16 v[20:23], v[84:87], v[180:183], v[20:23]
    v_mfma_f32_16x16x32_bf16 v[24:27], v[88:91], v[180:183], v[24:27]
    v_mfma_f32_16x16x32_bf16 v[28:31], v[92:95], v[180:183], v[28:31]
    s_waitcnt vmcnt(8) lgkmcnt(8)
    v_mfma_f32_16x16x32_bf16 v[16:19], v[192:195], v[184:187], v[16:19]
    v_mfma_f32_16x16x32_bf16 v[20:23], v[196:199], v[184:187], v[20:23]
    v_mfma_f32_16x16x32_bf16 v[24:27], v[200:203], v[184:187], v[24:27]
    v_mfma_f32_16x16x32_bf16 v[28:31], v[204:207], v[184:187], v[28:31]
    s_waitcnt vmcnt(7) lgkmcnt(0)
    v_mfma_f32_16x16x32_bf16 v[16:19], v[208:211], v[188:191], v[16:19]
    v_mfma_f32_16x16x32_bf16 v[20:23], v[212:215], v[188:191], v[20:23]
    v_mfma_f32_16x16x32_bf16 v[24:27], v[216:219], v[188:191], v[24:27]
    v_mfma_f32_16x16x32_bf16 v[28:31], v[220:223], v[188:191], v[28:31]
    s_nop 4
    v_cvt_pk_bf16_f32 v40, v16, v17
    v_cvt_pk_bf16_f32 v41, v18, v19
    v_cvt_pk_bf16_f32 v42, v20, v21
    v_cvt_pk_bf16_f32 v43, v22, v23
    buffer_store_dwordx4 v[40:43], v3, s[32:35], 0 offen sc1
    v_cvt_pk_bf16_f32 v44, v24, v25
    v_cvt_pk_bf16_f32 v45, v26, v27
    v_cvt_pk_bf16_f32 v46, v28, v29
    v_cvt_pk_bf16_f32 v47, v30, v31
    buffer_store_dwordx4 v[44:47], v3, s[32:35], 0 offen offset:1024 sc1
    v_dot2c_f32_bf16 v32, s70, v40
    v_dot2c_f32_bf16 v33, v40, v40
    v_dot2c_f32_bf16 v32, s70, v41
    v_dot2c_f32_bf16 v33, v41, v41
    v_dot2c_f32_bf16 v32, s70, v42
    v_dot2c_f32_bf16 v33, v42, v42
    v_dot2c_f32_bf16 v32, s70, v43
    v_dot2c_f32_bf16 v33, v43, v43
    v_dot2c_f32_bf16 v32, s70, v44
    v_dot2c_f32_bf16 v33, v44, v44
    v_dot2c_f32_bf16 v32, s70, v45
    v_dot2c_f32_bf16 v33, v45, v45
    v_dot2c_f32_bf16 v32, s70, v46
    v_dot2c_f32_bf16 v33, v46, v46
    v_dot2c_f32_bf16 v32, s70, v47
    v_dot2c_f32_bf16 v33, v47, v47
    s_nop 2
    v_permlane32_swap_b32 v32, v33
    v_add_f32 v32, v32, v33
    v_mov_b32 v33, v32
    s_nop 1
    v_permlane16_swap_b32 v32, v33
    v_add_f32 v32, v32, v33
    v_mov_b32 v33, v32
    s_nop 1
    v_permlane32_swap_b32 v32, v33
    s_mov_b64 exec, 0xffff
    buffer_store_dwordx2 v[32:33], v4, s[32:35], 0 offen sc1
    s_mov_b64 exec, -1
    v_lshlrev_b32 v64, 16, v40
    v_and_b32 v65, 0xffff0000, v40
    v_lshlrev_b32 v66, 16, v41
    v_and_b32 v67, 0xffff0000, v41
    v_lshlrev_b32 v68, 16, v42
    v_and_b32 v69, 0xffff0000, v42
    v_lshlrev_b32 v70, 16, v43
    v_and_b32 v71, 0xffff0000, v43
    v_lshlrev_b32 v72, 16, v44
    v_and_b32 v73, 0xffff0000, v44
    v_lshlrev_b32 v74, 16, v45
    v_and_b32 v75, 0xffff0000, v45
    v_lshlrev_b32 v76, 16, v46
    v_and_b32 v77, 0xffff0000, v46
    v_lshlrev_b32 v78, 16, v47
    v_and_b32 v79, 0xffff0000, v47
    v_lshlrev_b32 v80, 16, v56
    v_and_b32 v81, 0xffff0000, v56
    v_lshlrev_b32 v82, 16, v57
    v_and_b32 v83, 0xffff0000, v57
    v_lshlrev_b32 v84, 16, v58
    v_and_b32 v85, 0xffff0000, v58
    v_lshlrev_b32 v86, 16, v59
    v_and_b32 v87, 0xffff0000, v59
    v_lshlrev_b32 v88, 16, v60
    v_and_b32 v89, 0xffff0000, v60
    v_lshlrev_b32 v90, 16, v61
    v_and_b32 v91, 0xffff0000, v61
    v_lshlrev_b32 v92, 16, v62
    v_and_b32 v93, 0xffff0000, v62
    v_lshlrev_b32 v94, 16, v63
    v_and_b32 v95, 0xffff0000, v63
    v_pk_add_f32 v[64:65], v[64:65], v[80:81]
    v_pk_add_f32 v[66:67], v[66:67], v[82:83]
    v_pk_add_f32 v[68:69], v[68:69], v[84:85]
    v_pk_add_f32 v[70:71], v[70:71], v[86:87]
    v_pk_add_f32 v[72:73], v[72:73], v[88:89]
    v_pk_add_f32 v[74:75], v[74:75], v[90:91]
    v_pk_add_f32 v[76:77], v[76:77], v[92:93]
    v_pk_add_f32 v[78:79], v[78:79], v[94:95]
    v_accvgpr_write_b32 a224, v64
    v_accvgpr_write_b32 a225, v65
    v_accvgpr_write_b32 a226, v66
    v_accvgpr_write_b32 a227, v67
    v_accvgpr_write_b32 a228, v68
    v_accvgpr_write_b32 a229, v69
    v_accvgpr_write_b32 a230, v70
    v_accvgpr_write_b32 a231, v71
    v_accvgpr_write_b32 a232, v72
    v_accvgpr_write_b32 a233, v73
    v_accvgpr_write_b32 a234, v74
    v_accvgpr_write_b32 a235, v75
    v_accvgpr_write_b32 a236, v76
    v_accvgpr_write_b32 a237, v77
    v_accvgpr_write_b32 a238, v78
    v_accvgpr_write_b32 a239, v79
    v_lshrrev_b32 v2, 2, v0
    v_mul_u32_u24 v2, 224, v2
    v_and_b32 v3, 3, v0
    v_lshl_add_u32 v2, v3, 3, v2
    v_add_u32 v3, 43008, v2
    v_add_u32 v4, 98304, v2
    s_lshl_b32 s72, s51, 8
    s_add_u32 s72, s72, 8192
    v_mov_b32 v127, 1
    s_cmp_lg_u32 s48, 0
    s_waitcnt vmcnt(0) lgkmcnt(0)
    s_barrier
    s_cbranch_scc1 L_arr_6
    s_mov_b64 exec, 1
    buffer_atomic_add v127, off, s[32:35], s72 sc1
    s_mov_b64 exec, -1
L_arr_6:
    buffer_load_dwordx4 a[0:3], v5, s[32:35], 0 offen sc1
    buffer_load_dwordx4 a[4:7], v5, s[32:35], 0 offen offset:1024 sc1
    buffer_load_dwordx4 a[8:11], v5, s[32:35], 0 offen offset:2048 sc1
    buffer_load_dwordx4 a[12:15], v5, s[32:35], 0 offen offset:3072 sc1
    buffer_load_dwordx4 a[16:19], v5, s[32:35], s62 offen sc1
    buffer_load_dwordx4 a[20:23], v5, s[32:35], s62 offen offset:1024 sc1
    buffer_load_dwordx4 a[24:27], v5, s[32:35], s62 offen offset:2048 sc1
    buffer_load_dwordx4 a[28:31], v5, s[32:35], s62 offen offset:3072 sc1
    ds_read_b64_tr_b16 v[72:73], v103
    ds_read_b64_tr_b16 v[74:75], v103 offset:3584
    ds_read_b64_tr_b16 v[76:77], v103 offset:32
    ds_read_b64_tr_b16 v[78:79], v103 offset:3616
    ds_read_b64_tr_b16 v[80:81], v103 offset:64
    ds_read_b64_tr_b16 v[82:83], v103 offset:3648
    ds_read_b64_tr_b16 v[84:85], v103 offset:96
    ds_read_b64_tr_b16 v[86:87], v103 offset:3680
    ds_read_b64_tr_b16 v[88:89], v103 offset:128
    ds_read_b64_tr_b16 v[90:91], v103 offset:3712
    ds_read_b64_tr_b16 v[92:93], v103 offset:160
    ds_read_b64_tr_b16 v[94:95], v103 offset:3744
    ds_read_b64_tr_b16 v[96:97], v103 offset:192
    ds_read_b64_tr_b16 v[98:99], v103 offset:3776
    s_waitcnt lgkmcnt(6)
    v_dot2c_f32_bf16 v104, s70, v72
    v_dot2c_f32_bf16 v105, s70, v76
    v_dot2c_f32_bf16 v106, s70, v80
    v_dot2c_f32_bf16 v107, s70, v84
    v_dot2c_f32_bf16 v104, s70, v73
    v_dot2c_f32_bf16 v105, s70, v77
    v_dot2c_f32_bf16 v106, s70, v81
    v_dot2c_f32_bf16 v107, s70, v85
    v_dot2c_f32_bf16 v104, s70, v74
    v_dot2c_f32_bf16 v105, s70, v78
    v_dot2c_f32_bf16 v106, s70, v82
    v_dot2c_f32_bf16 v107, s70, v86
    v_dot2c_f32_bf16 v104, s70, v75
    v_dot2c_f32_bf16 v105, s70, v79
    v_dot2c_f32_bf16 v106, s70, v83
    v_dot2c_f32_bf16 v107, s70, v87
    s_waitcnt lgkmcnt(0)
    v_dot2c_f32_bf16 v108, s70, v88
    v_dot2c_f32_bf16 v109, s70, v92
    v_dot2c_f32_bf16 v110, s70, v96
    v_dot2c_f32_bf16 v108, s70, v89
    v_dot2c_f32_bf16 v109, s70, v93
    v_dot2c_f32_bf16 v110, s70, v97
    v_dot2c_f32_bf16 v108, s70, v90
    v_dot2c_f32_bf16 v109, s70, v94
    v_dot2c_f32_bf16 v110, s70, v98
    v_dot2c_f32_bf16 v108, s70, v91
    v_dot2c_f32_bf16 v109, s70, v95
    v_dot2c_f32_bf16 v110, s70, v99
    s_lshl_b32 s75, s48, 2
    s_add_u32 s75, s75, 94720
    v_bfe_u32 v6, v0, 4, 1
    v_lshlrev_b32 v6, 9, v6
    v_lshrrev_b32 v8, 5, v0
    v_lshl_add_u32 v6, v8, 8, v6
    v_and_b32 v8, 15, v0
    v_lshl_add_u32 v6, v8, 4, v6
    v_add_u32 v6, s75, v6
    v_permlane32_swap_b32 v104, v105
    v_permlane32_swap_b32 v106, v107
    v_permlane32_swap_b32 v108, v109
    v_permlane32_swap_b32 v110, v111
    v_add_f32 v104, v104, v105
    v_add_f32 v106, v106, v107
    v_add_f32 v108, v108, v109
    v_add_f32 v110, v110, v111
    v_permlane16_swap_b32 v104, v106
    s_nop 0
    v_permlane16_swap_b32 v108, v110
    v_add_f32 v104, v104, v106
    v_add_f32 v108, v108, v110
    ds_write_b32 v6, v104
    ds_write_b32 v6, v108 offset:1024
    s_lshl_b32 s58, s50, 2
    s_add_u32 s58, s58, s48
    s_lshl_b32 s58, s58, 1
    s_and_b32 s72, s58, 31
    s_lshl_b32 s72, s72, 14
    s_lshr_b32 s73, s58, 5
    s_lshl_b32 s73, s73, 21
    s_add_u32 s72, s72, s73
    s_add_u32 s72, s72, 4718592
    v_add_u32 v10, s72, v1
    v_add_u32 v11, 16384, v10
    s_lshl_b32 s72, s58, 10
    s_add_u32 s72, s72, 1179648
    v_lshlrev_b32 v7, 3, v0
    v_add_u32 v7, s72, v7
    s_lshr_b32 s72, s49, 1
    s_mul_i32 s72, s72, 7
    s_and_b32 s73, s58, 31
    s_mul_i32 s73, s73, 56
    s_add_u32 s72, s72, s73
    s_lshr_b32 s73, s58, 5
    s_mul_i32 s73, s73, 2112
    s_add_u32 s72, s72, s73
    s_lshl_b32 s72, s72, 10
    s_add_u32 s72, s72, 12582912
    v_add_u32 v12, s72, v1
    v_add_u32 v13, 57344, v12
    s_and_b32 s73, s49, 1
    s_lshl_b32 s60, s73, 12
    s_lshl_b32 s61, s73, 9
    v_add_u32 v8, 94720, v1
    v_lshlrev_b32 v9, 2, v0
    v_add_u32 v9, 96768, v9
    v_lshrrev_b32 v15, 4, v0
    v_lshlrev_b32 v15, 4, v15
    v_add_u32 v15, 96768, v15
    ds_read_b64_tr_b16 v[72:73], v2
    ds_read_b64_tr_b16 v[74:75], v2 offset:3584
    ds_read_b64_tr_b16 v[76:77], v2 offset:32
    ds_read_b64_tr_b16 v[78:79], v2 offset:3616
    ds_read_b64_tr_b16 v[80:81], v2 offset:64
    ds_read_b64_tr_b16 v[82:83], v2 offset:3648
    ds_read_b64_tr_b16 v[84:85], v2 offset:96
    ds_read_b64_tr_b16 v[86:87], v2 offset:3680
    ds_read_b64_tr_b16 v[88:89], v2 offset:128
    ds_read_b64_tr_b16 v[90:91], v2 offset:3712
    ds_read_b64_tr_b16 v[92:93], v2 offset:160
    ds_read_b64_tr_b16 v[94:95], v2 offset:3744
    s_waitcnt lgkmcnt(0)
    s_cmp_lg_u32 s48, 0
    s_cbranch_scc1 L_poll_7_done
    s_lshl_b32 s72, s50, 8
    s_add_u32 s72, s72, 8192
    s_mov_b64 exec, 1
    s_mov_b32 s74, 0
.p2align 6
L_poll_7:
    v_mov_b32 v127, 0
    buffer_atomic_add v127, off, s[32:35], s72 sc0 sc1
    s_add_u32 s74, s74, 1
    s_cmp_ge_u32 s74, 0x80000
    s_cbranch_scc1 L_poll_7_to
    s_waitcnt vmcnt(0)
    v_cmp_gt_u32 vcc, 16, v127
    s_cbranch_vccnz L_poll_7
L_poll_7_to:
    s_waitcnt vmcnt(0)
L_poll_7_out:
    s_mov_b64 exec, -1
L_poll_7_done:
    s_barrier
    buffer_load_dwordx4 v[128:131], v10, s[32:35], 0 offen sc1
    buffer_load_dwordx4 v[132:135], v11, s[32:35], 0 offen sc1
    buffer_load_dwordx4 v[136:139], v10, s[32:35], 0 offen offset:1024 sc1
    buffer_load_dwordx4 v[140:143], v11, s[32:35], 0 offen offset:1024 sc1
    buffer_load_dwordx4 v[144:147], v10, s[32:35], 0 offen offset:2048 sc1
    buffer_load_dwordx4 v[148:151], v11, s[32:35], 0 offen offset:2048 sc1
    buffer_load_dwordx4 v[152:155], v10, s[32:35], 0 offen offset:3072 sc1
    buffer_load_dwordx4 v[156:159], v11, s[32:35], 0 offen offset:3072 sc1
    buffer_load_dwordx4 v[160:163], v10, s[32:35], s62 offen sc1
    buffer_load_dwordx4 v[164:167], v11, s[32:35], s62 offen sc1
    buffer_load_dwordx2 v[112:113], v7, s[32:35], 0 offen sc1
    buffer_load_dwordx2 v[114:115], v7, s[32:35], 0 offen offset:512 sc1
    buffer_load_dwordx2 v[116:117], v7, s[32:35], 0 offen offset:1024 sc1
    buffer_load_dwordx2 v[118:119], v7, s[32:35], 0 offen offset:1536 sc1
    ds_read_b128 v[104:107], v8
    ds_read_b128 v[108:111], v8 offset:1024
    s_waitcnt lgkmcnt(0)
    v_pk_add_f32 v[104:105], v[104:105], v[106:107]
    v_pk_add_f32 v[108:109], v[108:109], v[110:111]
    v_add_f32 v104, v104, v105
    v_add_f32 v108, v108, v109
    ds_write_b32 v9, v104
    ds_write_b32 v9, v108 offset:256
    s_waitcnt vmcnt(12)
    v_mfma_f32_16x16x32_bf16 v[16:19], v[72:75], v[128:131], 0
    ds_read_b64_tr_b16 v[96:97], v2 offset:192
    ds_read_b64_tr_b16 v[98:99], v2 offset:3776
    v_mfma_f32_16x16x32_bf16 v[44:47], v[72:75], v[132:135], 0
    buffer_load_dwordx4 v[168:171], v10, s[32:35], s62 offen offset:1024 sc1
    v_mfma_f32_16x16x32_bf16 v[20:23], v[76:79], v[128:131], 0
    ds_read_b64_tr_b16 v[100:101], v2 offset:21504
    v_mfma_f32_16x16x32_bf16 v[48:51], v[76:79], v[132:135], 0
    ds_read_b64_tr_b16 v[102:103], v2 offset:25088
    v_mfma_f32_16x16x32_bf16 v[24:27], v[80:83], v[128:131], 0
    ds_read_b64_tr_b16 v[72:73], v2 offset:21536
    v_mfma_f32_16x16x32_bf16 v[52:55], v[80:83], v[132:135], 0
    ds_read_b64_tr_b16 v[74:75], v2 offset:25120
    v_mfma_f32_16x16x32_bf16 v[28:31], v[84:87], v[128:131], 0
    ds_read_b64_tr_b16 v[76:77], v2 offset:21568
    ds_read_b64_tr_b16 v[78:79], v2 offset:25152
    v_mfma_f32_16x16x32_bf16 v[56:59], v[84:87], v[132:135], 0
    buffer_load_dwordx4 v[172:175], v11, s[32:35], s62 offen offset:1024 sc1
    v_mfma_f32_16x16x32_bf16 v[32:35], v[88:91], v[128:131], 0
    ds_read_b64_tr_b16 v[80:81], v2 offset:21600
    v_mfma_f32_16x16x32_bf16 v[60:63], v[88:91], v[132:135], 0
    ds_read_b64_tr_b16 v[82:83], v2 offset:25184
    v_mfma_f32_16x16x32_bf16 v[36:39], v[92:95], v[128:131], 0
    ds_read_b64_tr_b16 v[84:85], v2 offset:21632
    ds_read_b64_tr_b16 v[86:87], v2 offset:25216
    v_mfma_f32_16x16x32_bf16 v[64:67], v[92:95], v[132:135], 0
    buffer_load_dwordx4 v[176:179], v10, s[32:35], s62 offen offset:2048 sc1
    s_waitcnt lgkmcnt(8)
    v_mfma_f32_16x16x32_bf16 v[40:43], v[96:99], v[128:131], 0
    ds_read_b64_tr_b16 v[88:89], v2 offset:21664
    v_mfma_f32_16x16x32_bf16 v[68:71], v[96:99], v[132:135], 0
    ds_read_b64_tr_b16 v[90:91], v2 offset:25248
    s_waitcnt vmcnt(13)
    v_mfma_f32_16x16x32_bf16 v[16:19], v[100:103], v[136:139], v[16:19]
    ds_read_b64_tr_b16 v[92:93], v2 offset:21696
    ds_read_b64_tr_b16 v[94:95], v2 offset:25280
    v_mfma_f32_16x16x32_bf16 v[44:47], v[100:103], v[140:143], v[44:47]
    buffer_load_dwordx4 v[180:183], v11, s[32:35], s62 offen offset:2048 sc1
    s_waitcnt lgkmcnt(8)
    v_mfma_f32_16x16x32_bf16 v[20:23], v[72:75], v[136:139], v[20:23]
    ds_read_b64_tr_b16 v[96:97], v3
    v_mfma_f32_16x16x32_bf16 v[48:51], v[72:75], v[140:143], v[48:51]
    ds_read_b64_tr_b16 v[98:99], v3 offset:3584
    v_mfma_f32_16x16x32_bf16 v[24:27], v[76:79], v[136:139], v[24:27]
    ds_read_b64_tr_b16 v[100:101], v3 offset:32
    v_mfma_f32_16x16x32_bf16 v[52:55], v[76:79], v[140:143], v[52:55]
    ds_read_b64_tr_b16 v[102:103], v3 offset:3616
    s_waitcnt lgkmcnt(8)
    v_mfma_f32_16x16x32_bf16 v[28:31], v[80:83], v[136:139], v[28:31]
    ds_read_b64_tr_b16 v[72:73], v3 offset:64
    ds_read_b64_tr_b16 v[74:75], v3 offset:3648
    v_mfma_f32_16x16x32_bf16 v[56:59], v[80:83], v[140:143], v[56:59]
    buffer_load_dwordx4 v[184:187], v10, s[32:35], s62 offen offset:3072 sc1
    v_mfma_f32_16x16x32_bf16 v[32:35], v[84:87], v[136:139], v[32:35]
    ds_read_b64_tr_b16 v[76:77], v3 offset:96
    v_mfma_f32_16x16x32_bf16 v[60:63], v[84:87], v[140:143], v[60:63]
    ds_read_b64_tr_b16 v[78:79], v3 offset:3680
    s_waitcnt lgkmcnt(8)
    v_mfma_f32_16x16x32_bf16 v[36:39], v[88:91], v[136:139], v[36:39]
    ds_read_b64_tr_b16 v[80:81], v3 offset:128
    ds_read_b64_tr_b16 v[82:83], v3 offset:3712
    v_mfma_f32_16x16x32_bf16 v[64:67], v[88:91], v[140:143], v[64:67]
    buffer_load_dwordx4 v[188:191], v11, s[32:35], s62 offen offset:3072 sc1
    v_mfma_f32_16x16x32_bf16 v[40:43], v[92:95], v[136:139], v[40:43]
    ds_read_b64_tr_b16 v[84:85], v3 offset:160
    v_mfma_f32_16x16x32_bf16 v[68:71], v[92:95], v[140:143], v[68:71]
    ds_read_b64_tr_b16 v[86:87], v3 offset:3744
    s_waitcnt vmcnt(14) lgkmcnt(8)
    v_mfma_f32_16x16x32_bf16 v[16:19], v[96:99], v[144:147], v[16:19]
    ds_read_b64_tr_b16 v[88:89], v3 offset:192
    ds_read_b64_tr_b16 v[90:91], v3 offset:3776
    v_mfma_f32_16x16x32_bf16 v[44:47], v[96:99], v[148:151], v[44:47]
    buffer_load_dwordx4 v[192:195], v10, s[32:35], s63 offen sc1
    v_mfma_f32_16x16x32_bf16 v[20:23], v[100:103], v[144:147], v[20:23]
    ds_read_b64_tr_b16 v[92:93], v3 offset:21504
    v_mfma_f32_16x16x32_bf16 v[48:51], v[100:103], v[148:151], v[48:51]
    ds_read_b64_tr_b16 v[94:95], v3 offset:25088
    s_waitcnt lgkmcnt(8)
    v_mfma_f32_16x16x32_bf16 v[24:27], v[72:75], v[144:147], v[24:27]
    ds_read_b64_tr_b16 v[96:97], v3 offset:21536
    v_mfma_f32_16x16x32_bf16 v[52:55], v[72:75], v[148:151], v[52:55]
    ds_read_b64_tr_b16 v[98:99], v3 offset:25120
    v_mfma_f32_16x16x32_bf16 v[28:31], v[76:79], v[144:147], v[28:31]
    ds_read_b64_tr_b16 v[100:101], v3 offset:21568
    ds_read_b64_tr_b16 v[102:103], v3 offset:25152
    v_mfma_f32_16x16x32_bf16 v[56:59], v[76:79], v[148:151], v[56:59]
    buffer_load_dwordx4 v[196:199], v11, s[32:35], s63 offen sc1
    s_waitcnt lgkmcnt(8)
    v_mfma_f32_16x16x32_bf16 v[32:35], v[80:83], v[144:147], v[32:35]
    ds_read_b64_tr_b16 v[72:73], v3 offset:21600
    v_mfma_f32_16x16x32_bf16 v[60:63], v[80:83], v[148:151], v[60:63]
    ds_read_b64_tr_b16 v[74:75], v3 offset:25184
    v_mfma_f32_16x16x32_bf16 v[36:39], v[84:87], v[144:147], v[36:39]
    ds_read_b64_tr_b16 v[76:77], v3 offset:21632
    ds_read_b64_tr_b16 v[78:79], v3 offset:25216
    v_mfma_f32_16x16x32_bf16 v[64:67], v[84:87], v[148:151], v[64:67]
    buffer_load_dwordx4 v[200:203], v10, s[32:35], s63 offen offset:1024 sc1
    s_waitcnt lgkmcnt(8)
    v_mfma_f32_16x16x32_bf16 v[40:43], v[88:91], v[144:147], v[40:43]
    ds_read_b64_tr_b16 v[80:81], v3 offset:21664
    v_mfma_f32_16x16x32_bf16 v[68:71], v[88:91], v[148:151], v[68:71]
    ds_read_b64_tr_b16 v[82:83], v3 offset:25248
    s_waitcnt vmcnt(15)
    v_mfma_f32_16x16x32_bf16 v[16:19], v[92:95], v[152:155], v[16:19]
    ds_read_b64_tr_b16 v[84:85], v3 offset:21696
    ds_read_b64_tr_b16 v[86:87], v3 offset:25280
    v_mfma_f32_16x16x32_bf16 v[44:47], v[92:95], v[156:159], v[44:47]
    buffer_load_dwordx4 v[204:207], v11, s[32:35], s63 offen offset:1024 sc1
    s_waitcnt lgkmcnt(8)
    v_mfma_f32_16x16x32_bf16 v[20:23], v[96:99], v[152:155], v[20:23]
    ds_read_b64_tr_b16 v[88:89], v2 offset:7168
    v_mfma_f32_16x16x32_bf16 v[48:51], v[96:99], v[156:159], v[48:51]
    ds_read_b64_tr_b16 v[90:91], v2 offset:10752
    v_mfma_f32_16x16x32_bf16 v[24:27], v[100:103], v[152:155], v[24:27]
    ds_read_b64_tr_b16 v[92:93], v2 offset:7200
    v_mfma_f32_16x16x32_bf16 v[52:55], v[100:103], v[156:159], v[52:55]
    ds_read_b64_tr_b16 v[94:95], v2 offset:10784
    s_waitcnt lgkmcnt(8)
    v_mfma_f32_16x16x32_bf16 v[28:31], v[72:75], v[152:155], v[28:31]
    ds_read_b64_tr_b16 v[96:97], v2 offset:7232
    ds_read_b64_tr_b16 v[98:99], v2 offset:10816
    v_mfma_f32_16x16x32_bf16 v[56:59], v[72:75], v[156:159], v[56:59]
    buffer_load_dwordx4 v[208:211], v10, s[32:35], s63 offen offset:2048 sc1
    v_mfma_f32_16x16x32_bf16 v[32:35], v[76:79], v[152:155], v[32:35]
    ds_read_b64_tr_b16 v[100:101], v2 offset:7264
    v_mfma_f32_16x16x32_bf16 v[60:63], v[76:79], v[156:159], v[60:63]
    ds_read_b64_tr_b16 v[102:103], v2 offset:10848
    s_waitcnt lgkmcnt(8)
    v_mfma_f32_16x16x32_bf16 v[36:39], v[80:83], v[152:155], v[36:39]
    ds_read_b64_tr_b16 v[72:73], v2 offset:7296
    ds_read_b64_tr_b16 v[74:75], v2 offset:10880
    v_mfma_f32_16x16x32_bf16 v[64:67], v[80:83], v[156:159], v[64:67]
    buffer_load_dwordx4 v[212:215], v11, s[32:35], s63 offen offset:2048 sc1
    v_mfma_f32_16x16x32_bf16 v[40:43], v[84:87], v[152:155], v[40:43]
    ds_read_b64_tr_b16 v[76:77], v2 offset:7328
    v_mfma_f32_16x16x32_bf16 v[68:71], v[84:87], v[156:159], v[68:71]
    ds_read_b64_tr_b16 v[78:79], v2 offset:10912
    s_waitcnt vmcnt(16) lgkmcnt(8)
    v_mfma_f32_16x16x32_bf16 v[16:19], v[88:91], v[160:163], v[16:19]
    ds_read_b64_tr_b16 v[80:81], v2 offset:7360
    ds_read_b64_tr_b16 v[82:83], v2 offset:10944
    v_mfma_f32_16x16x32_bf16 v[44:47], v[88:91], v[164:167], v[44:47]
    buffer_load_dwordx4 v[216:219], v10, s[32:35], s63 offen offset:3072 sc1
    v_mfma_f32_16x16x32_bf16 v[20:23], v[92:95], v[160:163], v[20:23]
    ds_read_b64_tr_b16 v[84:85], v2 offset:28672
    v_mfma_f32_16x16x32_bf16 v[48:51], v[92:95], v[164:167], v[48:51]
    ds_read_b64_tr_b16 v[86:87], v2 offset:32256
    s_waitcnt lgkmcnt(8)
    v_mfma_f32_16x16x32_bf16 v[24:27], v[96:99], v[160:163], v[24:27]
    ds_read_b64_tr_b16 v[88:89], v2 offset:28704
    v_mfma_f32_16x16x32_bf16 v[52:55], v[96:99], v[164:167], v[52:55]
    ds_read_b64_tr_b16 v[90:91], v2 offset:32288
    v_mfma_f32_16x16x32_bf16 v[28:31], v[100:103], v[160:163], v[28:31]
    ds_read_b64_tr_b16 v[92:93], v2 offset:28736
    ds_read_b64_tr_b16 v[94:95], v2 offset:32320
    v_mfma_f32_16x16x32_bf16 v[56:59], v[100:103], v[164:167], v[56:59]
    buffer_load_dwordx4 v[220:223], v11, s[32:35], s63 offen offset:3072 sc1
    s_waitcnt lgkmcnt(8)
    v_mfma_f32_16x16x32_bf16 v[32:35], v[72:75], v[160:163], v[32:35]
    ds_read_b64_tr_b16 v[96:97], v2 offset:28768
    v_mfma_f32_16x16x32_bf16 v[60:63], v[72:75], v[164:167], v[60:63]
    ds_read_b64_tr_b16 v[98:99], v2 offset:32352
    v_mfma_f32_16x16x32_bf16 v[36:39], v[76:79], v[160:163], v[36:39]
    ds_read_b64_tr_b16 v[100:101], v2 offset:28800
    ds_read_b64_tr_b16 v[102:103], v2 offset:32384
    v_mfma_f32_16x16x32_bf16 v[64:67], v[76:79], v[164:167], v[64:67]
    buffer_load_dwordx4 v[224:227], v10, s[32:35], s64 offen sc1
    s_waitcnt lgkmcnt(8)
    v_mfma_f32_16x16x32_bf16 v[40:43], v[80:83], v[160:163], v[40:43]
    ds_read_b64_tr_b16 v[72:73], v2 offset:28832
    v_mfma_f32_16x16x32_bf16 v[68:71], v[80:83], v[164:167], v[68:71]
    ds_read_b64_tr_b16 v[74:75], v2 offset:32416
    s_waitcnt vmcnt(13)
    v_mfma_f32_16x16x32_bf16 v[16:19], v[84:87], v[168:171], v[16:19]
    ds_read_b64_tr_b16 v[76:77], v2 offset:28864
    ds_read_b64_tr_b16 v[78:79], v2 offset:32448
    v_mfma_f32_16x16x32_bf16 v[44:47], v[84:87], v[172:175], v[44:47]
    buffer_load_dwordx4 v[228:231], v11, s[32:35], s64 offen sc1
    s_waitcnt lgkmcnt(8)
    v_mfma_f32_16x16x32_bf16 v[20:23], v[88:91], v[168:171], v[20:23]
    ds_read_b64_tr_b16 v[80:81], v3 offset:7168
    v_mfma_f32_16x16x32_bf16 v[48:51], v[88:91], v[172:175], v[48:51]
    ds_read_b64_tr_b16 v[82:83], v3 offset:10752
    v_add_f32 v112, v112, v114
    v_mfma_f32_16x16x32_bf16 v[24:27], v[92:95], v[168:171], v[24:27]
    ds_read_b64_tr_b16 v[84:85], v3 offset:7200
    v_mfma_f32_16x16x32_bf16 v[52:55], v[92:95], v[172:175], v[52:55]
    ds_read_b64_tr_b16 v[86:87], v3 offset:10784
    v_add_f32 v113, v113, v115
    s_waitcnt lgkmcnt(8)
    v_mfma_f32_16x16x32_bf16 v[28:31], v[96:99], v[168:171], v[28:31]
    ds_read_b64_tr_b16 v[88:89], v3 offset:7232
    ds_read_b64_tr_b16 v[90:91], v3 offset:10816
    v_mfma_f32_16x16x32_bf16 v[56:59], v[96:99], v[172:175], v[56:59]
    buffer_load_dwordx4 v[232:235], v10, s[32:35], s64 offen offset:1024 sc1
    v_mfma_f32_16x16x32_bf16 v[32:35], v[100:103], v[168:171], v[32:35]
    ds_read_b64_tr_b16 v[92:93], v3 offset:7264
    v_mfma_f32_16x16x32_bf16 v[60:63], v[100:103], v[172:175], v[60:63]
    ds_read_b64_tr_b16 v[94:95], v3 offset:10848
    s_waitcnt lgkmcnt(8)
    v_mfma_f32_16x16x32_bf16 v[36:39], v[72:75], v[168:171], v[36:39]
    ds_read_b64_tr_b16 v[96:97], v3 offset:7296
    ds_read_b64_tr_b16 v[98:99], v3 offset:10880
    v_mfma_f32_16x16x32_bf16 v[64:67], v[72:75], v[172:175], v[64:67]
    buffer_load_dwordx4 v[236:239], v11, s[32:35], s64 offen offset:1024 sc1
    v_mfma_f32_16x16x32_bf16 v[40:43], v[76:79], v[168:171], v[40:43]
    ds_read_b64_tr_b16 v[100:101], v3 offset:7328
    v_mfma_f32_16x16x32_bf16 v[68:71], v[76:79], v[172:175], v[68:71]
    ds_read_b64_tr_b16 v[102:103], v3 offset:10912
    v_permlane32_swap_b32 v112, v113
    s_waitcnt vmcnt(14) lgkmcnt(8)
    v_mfma_f32_16x16x32_bf16 v[16:19], v[80:83], v[176:179], v[16:19]
    ds_read_b64_tr_b16 v[72:73], v3 offset:7360
    ds_read_b64_tr_b16 v[74:75], v3 offset:10944
    v_mfma_f32_16x16x32_bf16 v[44:47], v[80:83], v[180:183], v[44:47]
    buffer_load_dwordx4 v[240:243], v10, s[32:35], s64 offen offset:2048 sc1
    v_mfma_f32_16x16x32_bf16 v[20:23], v[84:87], v[176:179], v[20:23]
    ds_read_b64_tr_b16 v[76:77], v3 offset:28672
    v_mfma_f32_16x16x32_bf16 v[48:51], v[84:87], v[180:183], v[48:51]
    ds_read_b64_tr_b16 v[78:79], v3 offset:32256
    v_add_f32 v112, v112, v113
    s_waitcnt lgkmcnt(8)
    v_mfma_f32_16x16x32_bf16 v[24:27], v[88:91], v[176:179], v[24:27]
    ds_read_b64_tr_b16 v[80:81], v3 offset:28704
    v_mfma_f32_16x16x32_bf16 v[52:55], v[88:91], v[180:183], v[52:55]
    ds_read_b64_tr_b16 v[82:83], v3 offset:32288
    v_mov_b32 v113, v112
    v_mfma_f32_16x16x32_bf16 v[28:31], v[92:95], v[176:179], v[28:31]
    ds_read_b64_tr_b16 v[84:85], v3 offset:28736
    ds_read_b64_tr_b16 v[86:87], v3 offset:32320
    v_mfma_f32_16x16x32_bf16 v[56:59], v[92:95], v[180:183], v[56:59]
    buffer_load_dwordx4 v[244:247], v11, s[32:35], s64 offen offset:2048 sc1
    s_waitcnt lgkmcnt(8)
    v_mfma_f32_16x16x32_bf16 v[32:35], v[96:99], v[176:179], v[32:35]
    ds_read_b64_tr_b16 v[88:89], v3 offset:28768
    v_mfma_f32_16x16x32_bf16 v[60:63], v[96:99], v[180:183], v[60:63]
    ds_read_b64_tr_b16 v[90:91], v3 offset:32352
    v_mfma_f32_16x16x32_bf16 v[36:39], v[100:103], v[176:179], v[36:39]
    ds_read_b64_tr_b16 v[92:93], v3 offset:28800
    ds_read_b64_tr_b16 v[94:95], v3 offset:32384
    v_mfma_f32_16x16x32_bf16 v[64:67], v[100:103], v[180:183], v[64:67]
    buffer_load_dwordx4 v[248:251], v10, s[32:35], s64 offen offset:3072 sc1
    s_waitcnt lgkmcnt(8)
    v_mfma_f32_16x16x32_bf16 v[40:43], v[72:75], v[176:179], v[40:43]
    ds_read_b64_tr_b16 v[96:97], v3 offset:28832
    v_mfma_f32_16x16x32_bf16 v[68:71], v[72:75], v[180:183], v[68:71]
    ds_read_b64_tr_b16 v[98:99], v3 offset:32416
    v_permlane16_swap_b32 v112, v113
    s_waitcnt vmcnt(15)
    v_mfma_f32_16x16x32_bf16 v[16:19], v[76:79], v[184:187], v[16:19]
    ds_read_b64_tr_b16 v[100:101], v3 offset:28864
    ds_read_b64_tr_b16 v[102:103], v3 offset:32448
    v_mfma_f32_16x16x32_bf16 v[44:47], v[76:79], v[188:191], v[44:47]
    buffer_load_dwordx4 v[252:255], v11, s[32:35], s64 offen offset:3072 sc1
    s_waitcnt lgkmcnt(8)
    v_mfma_f32_16x16x32_bf16 v[20:23], v[80:83], v[184:187], v[20:23]
    ds_read_b64_tr_b16 v[72:73], v2 offset:14336
    ds_read_b64_tr_b16 v[74:75], v2 offset:17920
    v_mfma_f32_16x16x32_bf16 v[48:51], v[80:83], v[188:191], v[48:51]
    buffer_load_dwordx4 a[32:35], v5, s[32:35], s63 offen sc1
    v_mfma_f32_16x16x32_bf16 v[24:27], v[84:87], v[184:187], v[24:27]
    ds_read_b64_tr_b16 v[76:77], v2 offset:14368
    v_mfma_f32_16x16x32_bf16 v[52:55], v[84:87], v[188:191], v[52:55]
    ds_read_b64_tr_b16 v[78:79], v2 offset:17952
    v_add_f32 v112, v112, v113
    s_waitcnt lgkmcnt(8)
    v_mfma_f32_16x16x32_bf16 v[28:31], v[88:91], v[184:187], v[28:31]
    ds_read_b64_tr_b16 v[80:81], v2 offset:14400
    ds_read_b64_tr_b16 v[82:83], v2 offset:17984
    v_mfma_f32_16x16x32_bf16 v[56:59], v[88:91], v[188:191], v[56:59]
    buffer_load_dwordx4 a[36:39], v5, s[32:35], s63 offen offset:1024 sc1
    v_mfma_f32_16x16x32_bf16 v[32:35], v[92:95], v[184:187], v[32:35]
    ds_read_b64_tr_b16 v[84:85], v2 offset:14432
    v_mfma_f32_16x16x32_bf16 v[60:63], v[92:95], v[188:191], v[60:63]
    ds_read_b64_tr_b16 v[86:87], v2 offset:18016
    v_mov_b32 v113, v112
    s_waitcnt lgkmcnt(8)
    v_mfma_f32_16x16x32_bf16 v[36:39], v[96:99], v[184:187], v[36:39]
    ds_read_b64_tr_b16 v[88:89], v2 offset:14464
    ds_read_b64_tr_b16 v[90:91], v2 offset:18048
    v_mfma_f32_16x16x32_bf16 v[64:67], v[96:99], v[188:191], v[64:67]
    buffer_load_dwordx4 a[40:43], v5, s[32:35], s63 offen offset:2048 sc1
    v_mfma_f32_16x16x32_bf16 v[40:43], v[100:103], v[184:187], v[40:43]
    ds_read_b64_tr_b16 v[92:93], v2 offset:14496
    v_mfma_f32_16x16x32_bf16 v[68:71], v[100:103], v[188:191], v[68:71]
    ds_read_b64_tr_b16 v[94:95], v2 offset:18080
    s_waitcnt vmcnt(17) lgkmcnt(8)
    v_mfma_f32_16x16x32_bf16 v[16:19], v[72:75], v[192:195], v[16:19]
    ds_read_b64_tr_b16 v[96:97], v2 offset:14528
    v_mfma_f32_16x16x32_bf16 v[44:47], v[72:75], v[196:199], v[44:47]
    ds_read_b64_tr_b16 v[98:99], v2 offset:18112
    v_permlane32_swap_b32 v112, v113
    v_mfma_f32_16x16x32_bf16 v[20:23], v[76:79], v[192:195], v[20:23]
    ds_read_b64_tr_b16 v[100:101], v2 offset:35840
    ds_read_b64_tr_b16 v[102:103], v2 offset:39424
    v_mfma_f32_16x16x32_bf16 v[48:51], v[76:79], v[196:199], v[48:51]
    buffer_load_dwordx4 a[44:47], v5, s[32:35], s63 offen offset:3072 sc1
    s_waitcnt lgkmcnt(8)
    v_mfma_f32_16x16x32_bf16 v[24:27], v[80:83], v[192:195], v[24:27]
    ds_read_b64_tr_b16 v[72:73], v2 offset:35872
    v_mfma_f32_16x16x32_bf16 v[52:55], v[80:83], v[196:199], v[52:55]
    ds_read_b64_tr_b16 v[74:75], v2 offset:39456
    v_mul_f32 v112, 0xbb000000, v112
    v_mfma_f32_16x16x32_bf16 v[28:31], v[84:87], v[192:195], v[28:31]
    ds_read_b64_tr_b16 v[76:77], v2 offset:35904
    ds_read_b64_tr_b16 v[78:79], v2 offset:39488
    v_mfma_f32_16x16x32_bf16 v[56:59], v[84:87], v[196:199], v[56:59]
    buffer_load_dwordx4 a[48:51], v5, s[32:35], s64 offen sc1
    s_waitcnt lgkmcnt(8)
    v_mfma_f32_16x16x32_bf16 v[32:35], v[88:91], v[192:195], v[32:35]
    ds_read_b64_tr_b16 v[80:81], v2 offset:35936
    v_mfma_f32_16x16x32_bf16 v[60:63], v[88:91], v[196:199], v[60:63]
    ds_read_b64_tr_b16 v[82:83], v2 offset:39520
    v_mul_f32 v113, 0x3b000000, v113
    v_mfma_f32_16x16x32_bf16 v[36:39], v[92:95], v[192:195], v[36:39]
    ds_read_b64_tr_b16 v[84:85], v2 offset:35968
    ds_read_b64_tr_b16 v[86:87], v2 offset:39552
    v_mfma_f32_16x16x32_bf16 v[64:67], v[92:95], v[196:199], v[64:67]
    buffer_load_dwordx4 a[52:55], v5, s[32:35], s64 offen offset:1024 sc1
    s_waitcnt lgkmcnt(8)
    v_mfma_f32_16x16x32_bf16 v[40:43], v[96:99], v[192:195], v[40:43]
    ds_read_b64_tr_b16 v[88:89], v2 offset:36000
    v_mfma_f32_16x16x32_bf16 v[68:71], v[96:99], v[196:199], v[68:71]
    ds_read_b64_tr_b16 v[90:91], v2 offset:39584
    v_fma_f32 v113, -v112, v112, v113
    s_waitcnt vmcnt(18)
    v_mfma_f32_16x16x32_bf16 v[16:19], v[100:103], v[200:203], v[16:19]
    ds_read_b64_tr_b16 v[92:93], v2 offset:36032
    v_mfma_f32_16x16x32_bf16 v[44:47], v[100:103], v[204:207], v[44:47]
    ds_read_b64_tr_b16 v[94:95], v2 offset:39616
    v_max_f32 v113, 0, v113
    s_waitcnt lgkmcnt(8)
    v_mfma_f32_16x16x32_bf16 v[20:23], v[72:75], v[200:203], v[20:23]
    ds_read_b64_tr_b16 v[96:97], v3 offset:14336
    ds_read_b64_tr_b16 v[98:99], v3 offset:17920
    v_mfma_f32_16x16x32_bf16 v[48:51], v[72:75], v[204:207], v[48:51]
    buffer_load_dwordx4 a[56:59], v5, s[32:35], s64 offen offset:2048 sc1
    v_mfma_f32_16x16x32_bf16 v[24:27], v[76:79], v[200:203], v[24:27]
    ds_read_b64_tr_b16 v[100:101], v3 offset:14368
    v_mfma_f32_16x16x32_bf16 v[52:55], v[76:79], v[204:207], v[52:55]
    ds_read_b64_tr_b16 v[102:103], v3 offset:17952
    v_add_f32 v113, 0x3727c5ac, v113
    s_waitcnt lgkmcnt(8)
    v_mfma_f32_16x16x32_bf16 v[28:31], v[80:83], v[200:203], v[28:31]
    ds_read_b64_tr_b16 v[72:73], v3 offset:14400
    ds_read_b64_tr_b16 v[74:75], v3 offset:17984
    v_mfma_f32_16x16x32_bf16 v[56:59], v[80:83], v[204:207], v[56:59]
    buffer_load_dwordx4 a[60:63], v5, s[32:35], s64 offen offset:3072 sc1
    v_mfma_f32_16x16x32_bf16 v[32:35], v[84:87], v[200:203], v[32:35]
    ds_read_b64_tr_b16 v[76:77], v3 offset:14432
    v_mfma_f32_16x16x32_bf16 v[60:63], v[84:87], v[204:207], v[60:63]
    ds_read_b64_tr_b16 v[78:79], v3 offset:18016
    v_rsq_f32 v120, v113
    s_waitcnt lgkmcnt(8)
    v_mfma_f32_16x16x32_bf16 v[36:39], v[88:91], v[200:203], v[36:39]
    ds_read_b64_tr_b16 v[80:81], v3 offset:14464
    ds_read_b64_tr_b16 v[82:83], v3 offset:18048
    v_mfma_f32_16x16x32_bf16 v[64:67], v[88:91], v[204:207], v[64:67]
    buffer_load_dwordx4 a[64:67], v5, s[32:35], s65 offen sc1
    v_mfma_f32_16x16x32_bf16 v[40:43], v[92:95], v[200:203], v[40:43]
    ds_read_b64_tr_b16 v[84:85], v3 offset:14496
    v_mfma_f32_16x16x32_bf16 v[68:71], v[92:95], v[204:207], v[68:71]
    ds_read_b64_tr_b16 v[86:87], v3 offset:18080
    s_waitcnt vmcnt(19) lgkmcnt(8)
    v_mfma_f32_16x16x32_bf16 v[16:19], v[96:99], v[208:211], v[16:19]
    ds_read_b64_tr_b16 v[88:89], v3 offset:14528
    v_mfma_f32_16x16x32_bf16 v[44:47], v[96:99], v[212:215], v[44:47]
    ds_read_b64_tr_b16 v[90:91], v3 offset:18112
    v_mul_f32 v122, v112, v120
    v_mfma_f32_16x16x32_bf16 v[20:23], v[100:103], v[208:211], v[20:23]
    ds_read_b64_tr_b16 v[92:93], v3 offset:35840
    ds_read_b64_tr_b16 v[94:95], v3 offset:39424
    v_mfma_f32_16x16x32_bf16 v[48:51], v[100:103], v[212:215], v[48:51]
    buffer_load_dwordx4 a[68:71], v5, s[32:35], s65 offen offset:1024 sc1
    s_waitcnt lgkmcnt(8)
    v_mfma_f32_16x16x32_bf16 v[24:27], v[72:75], v[208:211], v[24:27]
    ds_read_b64_tr_b16 v[96:97], v3 offset:35872
    v_mfma_f32_16x16x32_bf16 v[52:55], v[72:75], v[212:215], v[52:55]
    ds_read_b64_tr_b16 v[98:99], v3 offset:39456
    v_add_f32 v116, v116, v118
    v_mfma_f32_16x16x32_bf16 v[28:31], v[76:79], v[208:211], v[28:31]
    ds_read_b64_tr_b16 v[100:101], v3 offset:35904
    ds_read_b64_tr_b16 v[102:103], v3 offset:39488
    v_mfma_f32_16x16x32_bf16 v[56:59], v[76:79], v[212:215], v[56:59]
    buffer_load_dwordx4 a[72:75], v5, s[32:35], s65 offen offset:2048 sc1
    s_waitcnt lgkmcnt(8)
    v_mfma_f32_16x16x32_bf16 v[32:35], v[80:83], v[208:211], v[32:35]
    ds_read_b64_tr_b16 v[72:73], v3 offset:35936
    v_mfma_f32_16x16x32_bf16 v[60:63], v[80:83], v[212:215], v[60:63]
    ds_read_b64_tr_b16 v[74:75], v3 offset:39520
    v_add_f32 v117, v117, v119
    v_mfma_f32_16x16x32_bf16 v[36:39], v[84:87], v[208:211], v[36:39]
    ds_read_b64_tr_b16 v[76:77], v3 offset:35968
    ds_read_b64_tr_b16 v[78:79], v3 offset:39552
    v_mfma_f32_16x16x32_bf16 v[64:67], v[84:87], v[212:215], v[64:67]
    buffer_load_dwordx4 a[76:79], v5, s[32:35], s65 offen offset:3072 sc1
    s_waitcnt lgkmcnt(8)
    v_mfma_f32_16x16x32_bf16 v[40:43], v[88:91], v[208:211], v[40:43]
    ds_read_b64_tr_b16 v[80:81], v3 offset:36000
    v_mfma_f32_16x16x32_bf16 v[68:71], v[88:91], v[212:215], v[68:71]
    ds_read_b64_tr_b16 v[82:83], v3 offset:39584
    s_waitcnt vmcnt(20)
    v_mfma_f32_16x16x32_bf16 v[16:19], v[92:95], v[216:219], v[16:19]
    ds_read_b64_tr_b16 v[84:85], v3 offset:36032
    v_mfma_f32_16x16x32_bf16 v[44:47], v[92:95], v[220:223], v[44:47]
    ds_read_b64_tr_b16 v[86:87], v3 offset:39616
    v_permlane32_swap_b32 v116, v117
    s_waitcnt lgkmcnt(8)
    v_mfma_f32_16x16x32_bf16 v[20:23], v[96:99], v[216:219], v[20:23]
    ds_read_b64_tr_b16 v[88:89], v4
    ds_read_b64_tr_b16 v[90:91], v4 offset:3584
    v_mfma_f32_16x16x32_bf16 v[48:51], v[96:99], v[220:223], v[48:51]
    buffer_load_dwordx4 a[80:83], v5, s[32:35], s66 offen sc1
    v_mfma_f32_16x16x32_bf16 v[24:27], v[100:103], v[216:219], v[24:27]
    ds_read_b64_tr_b16 v[92:93], v4 offset:32
    v_mfma_f32_16x16x32_bf16 v[52:55], v[100:103], v[220:223], v[52:55]
    ds_read_b64_tr_b16 v[94:95], v4 offset:3616
    v_add_f32 v116, v116, v117
    s_waitcnt lgkmcnt(8)
    v_mfma_f32_16x16x32_bf16 v[28:31], v[72:75], v[216:219], v[28:31]
    ds_read_b64_tr_b16 v[96:97], v4 offset:64
    ds_read_b64_tr_b16 v[98:99], v4 offset:3648
    v_mfma_f32_16x16x32_bf16 v[56:59], v[72:75], v[220:223], v[56:59]
    buffer_load_dwordx4 a[84:87], v5, s[32:35], s66 offen offset:1024 sc1
    v_mfma_f32_16x16x32_bf16 v[32:35], v[76:79], v[216:219], v[32:35]
    ds_read_b64_tr_b16 v[100:101], v4 offset:96
    v_mfma_f32_16x16x32_bf16 v[60:63], v[76:79], v[220:223], v[60:63]
    ds_read_b64_tr_b16 v[102:103], v4 offset:3680
    v_mov_b32 v117, v116
    s_waitcnt lgkmcnt(8)
    v_mfma_f32_16x16x32_bf16 v[36:39], v[80:83], v[216:219], v[36:39]
    ds_read_b64_tr_b16 v[72:73], v4 offset:128
    ds_read_b64_tr_b16 v[74:75], v4 offset:3712
    v_mfma_f32_16x16x32_bf16 v[64:67], v[80:83], v[220:223], v[64:67]
    buffer_load_dwordx4 a[88:91], v5, s[32:35], s66 offen offset:2048 sc1
    v_mfma_f32_16x16x32_bf16 v[40:43], v[84:87], v[216:219], v[40:43]
    ds_read_b64_tr_b16 v[76:77], v4 offset:160
    v_mfma_f32_16x16x32_bf16 v[68:71], v[84:87], v[220:223], v[68:71]
    ds_read_b64_tr_b16 v[78:79], v4 offset:3744
    s_waitcnt vmcnt(21) lgkmcnt(8)
    v_mfma_f32_16x16x32_bf16 v[16:19], v[88:91], v[224:227], v[16:19]
    ds_read_b64_tr_b16 v[80:81], v4 offset:192
    v_mfma_f32_16x16x32_bf16 v[44:47], v[88:91], v[228:231], v[44:47]
    ds_read_b64_tr_b16 v[82:83], v4 offset:3776
    v_permlane16_swap_b32 v116, v117
    v_mfma_f32_16x16x32_bf16 v[20:23], v[92:95], v[224:227], v[20:23]
    ds_read_b64_tr_b16 v[84:85], v4 offset:7168
    ds_read_b64_tr_b16 v[86:87], v4 offset:10752
    v_mfma_f32_16x16x32_bf16 v[48:51], v[92:95], v[228:231], v[48:51]
    buffer_load_dwordx4 a[92:95], v5, s[32:35], s66 offen offset:3072 sc1
    s_waitcnt lgkmcnt(8)
    v_mfma_f32_16x16x32_bf16 v[24:27], v[96:99], v[224:227], v[24:27]
    ds_read_b64_tr_b16 v[88:89], v4 offset:7200
    v_mfma_f32_16x16x32_bf16 v[52:55], v[96:99], v[228:231], v[52:55]
    ds_read_b64_tr_b16 v[90:91], v4 offset:10784
    v_add_f32 v116, v116, v117
    v_mfma_f32_16x16x32_bf16 v[28:31], v[100:103], v[224:227], v[28:31]
    ds_read_b64_tr_b16 v[92:93], v4 offset:7232
    ds_read_b64_tr_b16 v[94:95], v4 offset:10816
    v_mfma_f32_16x16x32_bf16 v[56:59], v[100:103], v[228:231], v[56:59]
    buffer_load_dwordx4 a[96:99], v5, s[32:35], s67 offen sc1
    s_waitcnt lgkmcnt(8)
    v_mfma_f32_16x16x32_bf16 v[32:35], v[72:75], v[224:227], v[32:35]
    ds_read_b64_tr_b16 v[96:97], v4 offset:7264
    v_mfma_f32_16x16x32_bf16 v[60:63], v[72:75], v[228:231], v[60:63]
    ds_read_b64_tr_b16 v[98:99], v4 offset:10848
    v_mov_b32 v117, v116
    v_mfma_f32_16x16x32_bf16 v[36:39], v[76:79], v[224:227], v[36:39]
    ds_read_b64_tr_b16 v[100:101], v4 offset:7296
    ds_read_b64_tr_b16 v[102:103], v4 offset:10880
    v_mfma_f32_16x16x32_bf16 v[64:67], v[76:79], v[228:231], v[64:67]
    buffer_load_dwordx4 a[100:103], v5, s[32:35], s67 offen offset:1024 sc1
    s_waitcnt lgkmcnt(8)
    v_mfma_f32_16x16x32_bf16 v[40:43], v[80:83], v[224:227], v[40:43]
    ds_read_b64_tr_b16 v[72:73], v4 offset:7328
    v_mfma_f32_16x16x32_bf16 v[68:71], v[80:83], v[228:231], v[68:71]
    ds_read_b64_tr_b16 v[74:75], v4 offset:10912
    s_waitcnt vmcnt(22)
    v_mfma_f32_16x16x32_bf16 v[16:19], v[84:87], v[232:235], v[16:19]
    ds_read_b64_tr_b16 v[76:77], v4 offset:7360
    v_mfma_f32_16x16x32_bf16 v[44:47], v[84:87], v[236:239], v[44:47]
    ds_read_b64_tr_b16 v[78:79], v4 offset:10944
    v_permlane32_swap_b32 v116, v117
    s_waitcnt lgkmcnt(8)
    v_mfma_f32_16x16x32_bf16 v[20:23], v[88:91], v[232:235], v[20:23]
    ds_read_b64_tr_b16 v[80:81], v4 offset:14336
    ds_read_b64_tr_b16 v[82:83], v4 offset:17920
    v_mfma_f32_16x16x32_bf16 v[48:51], v[88:91], v[236:239], v[48:51]
    buffer_load_dwordx4 a[104:107], v5, s[32:35], s67 offen offset:2048 sc1
    v_mfma_f32_16x16x32_bf16 v[24:27], v[92:95], v[232:235], v[24:27]
    ds_read_b64_tr_b16 v[84:85], v4 offset:14368
    v_mfma_f32_16x16x32_bf16 v[52:55], v[92:95], v[236:239], v[52:55]
    ds_read_b64_tr_b16 v[86:87], v4 offset:17952
    v_mul_f32 v116, 0xbb000000, v116
    s_waitcnt lgkmcnt(8)
    v_mfma_f32_16x16x32_bf16 v[28:31], v[96:99], v[232:235], v[28:31]
    ds_read_b64_tr_b16 v[88:89], v4 offset:14400
    ds_read_b64_tr_b16 v[90:91], v4 offset:17984
    v_mfma_f32_16x16x32_bf16 v[56:59], v[96:99], v[236:239], v[56:59]
    buffer_load_dwordx4 a[108:111], v5, s[32:35], s67 offen offset:3072 sc1
    v_mfma_f32_16x16x32_bf16 v[32:35], v[100:103], v[232:235], v[32:35]
    ds_read_b64_tr_b16 v[92:93], v4 offset:14432
    v_mfma_f32_16x16x32_bf16 v[60:63], v[100:103], v[236:239], v[60:63]
    ds_read_b64_tr_b16 v[94:95], v4 offset:18016
    v_mul_f32 v117, 0x3b000000, v117
    s_waitcnt lgkmcnt(8)
    v_mfma_f32_16x16x32_bf16 v[36:39], v[72:75], v[232:235], v[36:39]
    ds_read_b64_tr_b16 v[96:97], v4 offset:14464
    ds_read_b64_tr_b16 v[98:99], v4 offset:18048
    v_mfma_f32_16x16x32_bf16 v[64:67], v[72:75], v[236:239], v[64:67]
    buffer_load_dwordx4 a[112:115], v5, s[32:35], s68 offen sc1
    v_mfma_f32_16x16x32_bf16 v[40:43], v[76:79], v[232:235], v[40:43]
    ds_read_b64_tr_b16 v[100:101], v4 offset:14496
    v_mfma_f32_16x16x32_bf16 v[68:71], v[76:79], v[236:239], v[68:71]
    ds_read_b64_tr_b16 v[102:103], v4 offset:18080
    v_fma_f32 v117, -v116, v116, v117
    s_waitcnt vmcnt(23) lgkmcnt(8)
    v_mfma_f32_16x16x32_bf16 v[16:19], v[80:83], v[240:243], v[16:19]
    ds_read_b64_tr_b16 v[72:73], v4 offset:14528
    v_mfma_f32_16x16x32_bf16 v[44:47], v[80:83], v[244:247], v[44:47]
    ds_read_b64_tr_b16 v[74:75], v4 offset:18112
    v_max_f32 v117, 0, v117
    v_mfma_f32_16x16x32_bf16 v[20:23], v[84:87], v[240:243], v[20:23]
    ds_read_b64_tr_b16 v[76:77], v4 offset:21504
    ds_read_b64_tr_b16 v[78:79], v4 offset:25088
    v_mfma_f32_16x16x32_bf16 v[48:51], v[84:87], v[244:247], v[48:51]
    buffer_load_dwordx4 a[116:119], v5, s[32:35], s68 offen offset:1024 sc1
    s_waitcnt lgkmcnt(8)
    v_mfma_f32_16x16x32_bf16 v[24:27], v[88:91], v[240:243], v[24:27]
    ds_read_b64_tr_b16 v[80:81], v4 offset:21536
    v_mfma_f32_16x16x32_bf16 v[52:55], v[88:91], v[244:247], v[52:55]
    ds_read_b64_tr_b16 v[82:83], v4 offset:25120
    v_add_f32 v117, 0x3727c5ac, v117
    v_mfma_f32_16x16x32_bf16 v[28:31], v[92:95], v[240:243], v[28:31]
    ds_read_b64_tr_b16 v[84:85], v4 offset:21568
    ds_read_b64_tr_b16 v[86:87], v4 offset:25152
    v_mfma_f32_16x16x32_bf16 v[56:59], v[92:95], v[244:247], v[56:59]
    buffer_load_dwordx4 a[120:123], v5, s[32:35], s68 offen offset:2048 sc1
    s_waitcnt lgkmcnt(8)
    v_mfma_f32_16x16x32_bf16 v[32:35], v[96:99], v[240:243], v[32:35]
    ds_read_b64_tr_b16 v[88:89], v4 offset:21600
    v_mfma_f32_16x16x32_bf16 v[60:63], v[96:99], v[244:247], v[60:63]
    ds_read_b64_tr_b16 v[90:91], v4 offset:25184
    v_rsq_f32 v124, v117
    v_mfma_f32_16x16x32_bf16 v[36:39], v[100:103], v[240:243], v[36:39]
    ds_read_b64_tr_b16 v[92:93], v4 offset:21632
    ds_read_b64_tr_b16 v[94:95], v4 offset:25216
    v_mfma_f32_16x16x32_bf16 v[64:67], v[100:103], v[244:247], v[64:67]
    buffer_load_dwordx4 a[124:127], v5, s[32:35], s68 offen offset:3072 sc1
    s_waitcnt lgkmcnt(8)
    v_mfma_f32_16x16x32_bf16 v[40:43], v[72:75], v[240:243], v[40:43]
    ds_read_b64_tr_b16 v[96:97], v4 offset:21664
    v_mfma_f32_16x16x32_bf16 v[68:71], v[72:75], v[244:247], v[68:71]
    ds_read_b64_tr_b16 v[98:99], v4 offset:25248
    s_waitcnt vmcnt(24)
    v_mfma_f32_16x16x32_bf16 v[16:19], v[76:79], v[248:251], v[16:19]
    ds_read_b64_tr_b16 v[100:101], v4 offset:21696
    v_mfma_f32_16x16x32_bf16 v[44:47], v[76:79], v[252:255], v[44:47]
    ds_read_b64_tr_b16 v[102:103], v4 offset:25280
    v_mul_f32 v126, v116, v124
    s_waitcnt lgkmcnt(8)
    v_mfma_f32_16x16x32_bf16 v[20:23], v[80:83], v[248:251], v[20:23]
    ds_read_b128 v[128:131], v15
    ds_read_b128 v[132:135], v15 offset:512
    v_mfma_f32_16x16x32_bf16 v[48:51], v[80:83], v[252:255], v[48:51]
    buffer_load_dwordx4 a[128:131], v5, s[32:35], s69 offen sc1
    v_mfma_f32_16x16x32_bf16 v[24:27], v[84:87], v[248:251], v[24:27]
    ds_read_b128 v[136:139], v15 offset:64
    ds_read_b128 v[140:143], v15 offset:576
    v_mfma_f32_16x16x32_bf16 v[52:55], v[84:87], v[252:255], v[52:55]
    s_mov_b32 s74, 0xbdd2d3e8
    s_waitcnt lgkmcnt(8)
    v_mfma_f32_16x16x32_bf16 v[28:31], v[88:91], v[248:251], v[28:31]
    ds_read_b128 v[144:147], v15 offset:128
    ds_read_b128 v[148:151], v15 offset:640
    v_mfma_f32_16x16x32_bf16 v[56:59], v[88:91], v[252:255], v[56:59]
    buffer_load_dwordx4 a[132:135], v5, s[32:35], s69 offen offset:1024 sc1
    v_mfma_f32_16x16x32_bf16 v[32:35], v[92:95], v[248:251], v[32:35]
    ds_read_b128 v[152:155], v15 offset:192
    ds_read_b128 v[156:159], v15 offset:704
    v_mfma_f32_16x16x32_bf16 v[60:63], v[92:95], v[252:255], v[60:63]
    v_mov_b32 v110, 0xc0135761
    s_waitcnt lgkmcnt(8)
    v_mfma_f32_16x16x32_bf16 v[36:39], v[96:99], v[248:251], v[36:39]
    ds_read_b128 v[160:163], v15 offset:256
    ds_read_b128 v[164:167], v15 offset:768
    v_mfma_f32_16x16x32_bf16 v[64:67], v[96:99], v[252:255], v[64:67]
    buffer_load_dwordx4 a[136:139], v5, s[32:35], s69 offen offset:2048 sc1
    v_mfma_f32_16x16x32_bf16 v[40:43], v[100:103], v[248:251], v[40:43]
    ds_read_b128 v[168:171], v15 offset:320
    ds_read_b128 v[172:175], v15 offset:832
    v_mfma_f32_16x16x32_bf16 v[68:71], v[100:103], v[252:255], v[68:71]
    v_lshlrev_b32 v11, 3, v0
    v_sub_u32 v10, v12, v11
    v_sub_u32 v11, v13, v11
    ds_read_b128 v[176:179], v15 offset:384
    ds_read_b128 v[180:183], v15 offset:896
    s_waitcnt lgkmcnt(12)
    v_pk_fma_f32 v[192:193], v[128:129], v[122:123], v[132:133] op_sel_hi:[1,0,1]
    v_pk_fma_f32 v[194:195], v[130:131], v[122:123], v[134:135] op_sel_hi:[1,0,1]
    v_pk_fma_f32 v[196:197], v[128:129], v[126:127], v[132:133] op_sel_hi:[1,0,1]
    v_pk_fma_f32 v[198:199], v[130:131], v[126:127], v[134:135] op_sel_hi:[1,0,1]
    v_pk_fma_f32 v[16:17], v[16:17], v[120:121], v[192:193] op_sel_hi:[1,0,1]
    v_pk_fma_f32 v[18:19], v[18:19], v[120:121], v[194:195] op_sel_hi:[1,0,1]
    v_pk_fma_f32 v[44:45], v[44:45], v[124:125], v[196:197] op_sel_hi:[1,0,1]
    v_pk_fma_f32 v[46:47], v[46:47], v[124:125], v[198:199] op_sel_hi:[1,0,1]
    buffer_load_dwordx4 a[140:143], v5, s[32:35], s69 offen offset:3072 sc1
    v_pk_mul_f32 v[192:193], v[16:17], v[16:17]
    v_pk_mul_f32 v[194:195], v[18:19], v[18:19]
    v_pk_mul_f32 v[196:197], v[44:45], v[44:45]
    v_pk_mul_f32 v[198:199], v[46:47], v[46:47]
    v_pk_fma_f32 v[192:193], v[192:193], s[74:75], v[110:111] op_sel_hi:[1,0,0]
    v_pk_fma_f32 v[194:195], v[194:195], s[74:75], v[110:111] op_sel_hi:[1,0,0]
    v_pk_fma_f32 v[196:197], v[196:197], s[74:75], v[110:111] op_sel_hi:[1,0,0]
    v_pk_fma_f32 v[198:199], v[198:199], s[74:75], v[110:111] op_sel_hi:[1,0,0]
    buffer_load_dwordx4 a[144:147], v5, s[32:35], s96 offen sc1
    v_pk_mul_f32 v[192:193], v[192:193], v[16:17]
    v_pk_mul_f32 v[194:195], v[194:195], v[18:19]
    v_pk_mul_f32 v[196:197], v[196:197], v[44:45]
    v_pk_mul_f32 v[198:199], v[198:199], v[46:47]
    v_exp_f32 v192, v192
    v_exp_f32 v193, v193
    v_exp_f32 v194, v194
    v_exp_f32 v195, v195
    buffer_load_dwordx4 a[148:151], v5, s[32:35], s96 offen offset:1024 sc1
    v_exp_f32 v196, v196
    v_exp_f32 v197, v197
    v_exp_f32 v198, v198
    v_exp_f32 v199, v199
    v_pk_add_f32 v[192:193], v[192:193], 1.0 op_sel_hi:[1,0]
    v_pk_add_f32 v[194:195], v[194:195], 1.0 op_sel_hi:[1,0]
    v_pk_add_f32 v[196:197], v[196:197], 1.0 op_sel_hi:[1,0]
    v_pk_add_f32 v[198:199], v[198:199], 1.0 op_sel_hi:[1,0]
    buffer_load_dwordx4 a[152:155], v5, s[32:35], s96 offen offset:2048 sc1
    v_rcp_f32 v192, v192
    v_rcp_f32 v193, v193
    v_rcp_f32 v194, v194
    v_rcp_f32 v195, v195
    v_rcp_f32 v196, v196
    v_rcp_f32 v197, v197
    v_rcp_f32 v198, v198
    v_rcp_f32 v199, v199
    buffer_load_dwordx4 a[156:159], v5, s[32:35], s96 offen offset:3072 sc1
    v_pk_mul_f32 v[16:17], v[16:17], v[192:193]
    v_pk_mul_f32 v[18:19], v[18:19], v[194:195]
    v_pk_mul_f32 v[44:45], v[44:45], v[196:197]
    v_pk_mul_f32 v[46:47], v[46:47], v[198:199]
    v_cvt_pk_bf16_f32 v200, v16, v17
    v_cvt_pk_bf16_f32 v201, v18, v19
    v_cvt_pk_bf16_f32 v204, v44, v45
    v_cvt_pk_bf16_f32 v205, v46, v47
    buffer_load_dwordx4 a[160:163], v5, s[32:35], s97 offen sc1
    s_waitcnt lgkmcnt(10)
    v_pk_fma_f32 v[192:193], v[136:137], v[122:123], v[140:141] op_sel_hi:[1,0,1]
    v_pk_fma_f32 v[194:195], v[138:139], v[122:123], v[142:143] op_sel_hi:[1,0,1]
    v_pk_fma_f32 v[196:197], v[136:137], v[126:127], v[140:141] op_sel_hi:[1,0,1]
    v_pk_fma_f32 v[198:199], v[138:139], v[126:127], v[142:143] op_sel_hi:[1,0,1]
    v_pk_fma_f32 v[20:21], v[20:21], v[120:121], v[192:193] op_sel_hi:[1,0,1]
    v_pk_fma_f32 v[22:23], v[22:23], v[120:121], v[194:195] op_sel_hi:[1,0,1]
    v_pk_fma_f32 v[48:49], v[48:49], v[124:125], v[196:197] op_sel_hi:[1,0,1]
    v_pk_fma_f32 v[50:51], v[50:51], v[124:125], v[198:199] op_sel_hi:[1,0,1]
    buffer_load_dwordx4 a[164:167], v5, s[32:35], s97 offen offset:1024 sc1
    v_pk_mul_f32 v[192:193], v[20:21], v[20:21]
    v_pk_mul_f32 v[194:195], v[22:23], v[22:23]
    v_pk_mul_f32 v[196:197], v[48:49], v[48:49]
    v_pk_mul_f32 v[198:199], v[50:51], v[50:51]
    v_pk_fma_f32 v[192:193], v[192:193], s[74:75], v[110:111] op_sel_hi:[1,0,0]
    v_pk_fma_f32 v[194:195], v[194:195], s[74:75], v[110:111] op_sel_hi:[1,0,0]
    v_pk_fma_f32 v[196:197], v[196:197], s[74:75], v[110:111] op_sel_hi:[1,0,0]
    v_pk_fma_f32 v[198:199], v[198:199], s[74:75], v[110:111] op_sel_hi:[1,0,0]
    buffer_load_dwordx4 a[168:171], v5, s[32:35], s97 offen offset:2048 sc1
    v_pk_mul_f32 v[192:193], v[192:193], v[20:21]
    v_pk_mul_f32 v[194:195], v[194:195], v[22:23]
    v_pk_mul_f32 v[196:197], v[196:197], v[48:49]
    v_pk_mul_f32 v[198:199], v[198:199], v[50:51]
    v_exp_f32 v192, v192
    v_exp_f32 v193, v193
    v_exp_f32 v194, v194
    v_exp_f32 v195, v195
    buffer_load_dwordx4 a[172:175], v5, s[32:35], s97 offen offset:3072 sc1
    v_exp_f32 v196, v196
    v_exp_f32 v197, v197
    v_exp_f32 v198, v198
    v_exp_f32 v199, v199
    v_pk_add_f32 v[192:193], v[192:193], 1.0 op_sel_hi:[1,0]
    v_pk_add_f32 v[194:195], v[194:195], 1.0 op_sel_hi:[1,0]
    v_pk_add_f32 v[196:197], v[196:197], 1.0 op_sel_hi:[1,0]
    v_pk_add_f32 v[198:199], v[198:199], 1.0 op_sel_hi:[1,0]
    buffer_load_dwordx4 a[176:179], v5, s[32:35], s98 offen sc1
    v_rcp_f32 v192, v192
    v_rcp_f32 v193, v193
    v_rcp_f32 v194, v194
    v_rcp_f32 v195, v195
    v_rcp_f32 v196, v196
    v_rcp_f32 v197, v197
    v_rcp_f32 v198, v198
    v_rcp_f32 v199, v199
    buffer_load_dwordx4 a[180:183], v5, s[32:35], s98 offen offset:1024 sc1
    v_pk_mul_f32 v[20:21], v[20:21], v[192:193]
    v_pk_mul_f32 v[22:23], v[22:23], v[194:195]
    v_pk_mul_f32 v[48:49], v[48:49], v[196:197]
    v_pk_mul_f32 v[50:51], v[50:51], v[198:199]
    v_cvt_pk_bf16_f32 v202, v20, v21
    v_cvt_pk_bf16_f32 v203, v22, v23
    v_cvt_pk_bf16_f32 v206, v48, v49
    v_cvt_pk_bf16_f32 v207, v50, v51
    buffer_load_dwordx4 a[184:187], v5, s[32:35], s98 offen offset:2048 sc1
    buffer_store_dwordx4 v[200:203], v12, s[32:35], s60 offen sc1
    buffer_store_dwordx4 v[204:207], v13, s[32:35], s60 offen sc1
    s_waitcnt lgkmcnt(8)
    v_pk_fma_f32 v[192:193], v[144:145], v[122:123], v[148:149] op_sel_hi:[1,0,1]
    v_pk_fma_f32 v[194:195], v[146:147], v[122:123], v[150:151] op_sel_hi:[1,0,1]
    v_pk_fma_f32 v[196:197], v[144:145], v[126:127], v[148:149] op_sel_hi:[1,0,1]
    v_pk_fma_f32 v[198:199], v[146:147], v[126:127], v[150:151] op_sel_hi:[1,0,1]
    v_pk_fma_f32 v[24:25], v[24:25], v[120:121], v[192:193] op_sel_hi:[1,0,1]
    v_pk_fma_f32 v[26:27], v[26:27], v[120:121], v[194:195] op_sel_hi:[1,0,1]
    v_pk_fma_f32 v[52:53], v[52:53], v[124:125], v[196:197] op_sel_hi:[1,0,1]
    v_pk_fma_f32 v[54:55], v[54:55], v[124:125], v[198:199] op_sel_hi:[1,0,1]
    buffer_load_dwordx4 a[188:191], v5, s[32:35], s98 offen offset:3072 sc1
    v_pk_mul_f32 v[192:193], v[24:25], v[24:25]
    v_pk_mul_f32 v[194:195], v[26:27], v[26:27]
    v_pk_mul_f32 v[196:197], v[52:53], v[52:53]
    v_pk_mul_f32 v[198:199], v[54:55], v[54:55]
    v_pk_fma_f32 v[192:193], v[192:193], s[74:75], v[110:111] op_sel_hi:[1,0,0]
    v_pk_fma_f32 v[194:195], v[194:195], s[74:75], v[110:111] op_sel_hi:[1,0,0]
    v_pk_fma_f32 v[196:197], v[196:197], s[74:75], v[110:111] op_sel_hi:[1,0,0]
    v_pk_fma_f32 v[198:199], v[198:199], s[74:75], v[110:111] op_sel_hi:[1,0,0]
    v_pk_mul_f32 v[192:193], v[192:193], v[24:25]
    v_pk_mul_f32 v[194:195], v[194:195], v[26:27]
    v_pk_mul_f32 v[196:197], v[196:197], v[52:53]
    v_pk_mul_f32 v[198:199], v[198:199], v[54:55]
    v_exp_f32 v192, v192
    v_exp_f32 v193, v193
    v_exp_f32 v194, v194
    v_exp_f32 v195, v195
    v_exp_f32 v196, v196
    v_exp_f32 v197, v197
    v_exp_f32 v198, v198
    v_exp_f32 v199, v199
    v_pk_add_f32 v[192:193], v[192:193], 1.0 op_sel_hi:[1,0]
    v_pk_add_f32 v[194:195], v[194:195], 1.0 op_sel_hi:[1,0]
    v_pk_add_f32 v[196:197], v[196:197], 1.0 op_sel_hi:[1,0]
    v_pk_add_f32 v[198:199], v[198:199], 1.0 op_sel_hi:[1,0]
    v_rcp_f32 v192, v192
    v_rcp_f32 v193, v193
    v_rcp_f32 v194, v194
    v_rcp_f32 v195, v195
    v_rcp_f32 v196, v196
    v_rcp_f32 v197, v197
    v_rcp_f32 v198, v198
    v_rcp_f32 v199, v199
    v_pk_mul_f32 v[24:25], v[24:25], v[192:193]
    v_pk_mul_f32 v[26:27], v[26:27], v[194:195]
    v_pk_mul_f32 v[52:53], v[52:53], v[196:197]
    v_pk_mul_f32 v[54:55], v[54:55], v[198:199]
    v_cvt_pk_bf16_f32 v208, v24, v25
    v_cvt_pk_bf16_f32 v209, v26, v27
    v_cvt_pk_bf16_f32 v212, v52, v53
    v_cvt_pk_bf16_f32 v213, v54, v55
    s_waitcnt lgkmcnt(6)
    v_pk_fma_f32 v[192:193], v[152:153], v[122:123], v[156:157] op_sel_hi:[1,0,1]
    v_pk_fma_f32 v[194:195], v[154:155], v[122:123], v[158:159] op_sel_hi:[1,0,1]
    v_pk_fma_f32 v[196:197], v[152:153], v[126:127], v[156:157] op_sel_hi:[1,0,1]
    v_pk_fma_f32 v[198:199], v[154:155], v[126:127], v[158:159] op_sel_hi:[1,0,1]
    v_pk_fma_f32 v[28:29], v[28:29], v[120:121], v[192:193] op_sel_hi:[1,0,1]
    v_pk_fma_f32 v[30:31], v[30:31], v[120:121], v[194:195] op_sel_hi:[1,0,1]
    v_pk_fma_f32 v[56:57], v[56:57], v[124:125], v[196:197] op_sel_hi:[1,0,1]
    v_pk_fma_f32 v[58:59], v[58:59], v[124:125], v[198:199] op_sel_hi:[1,0,1]
    v_pk_mul_f32 v[192:193], v[28:29], v[28:29]
    v_pk_mul_f32 v[194:195], v[30:31], v[30:31]
    v_pk_mul_f32 v[196:197], v[56:57], v[56:57]
    v_pk_mul_f32 v[198:199], v[58:59], v[58:59]
    v_pk_fma_f32 v[192:193], v[192:193], s[74:75], v[110:111] op_sel_hi:[1,0,0]
    v_pk_fma_f32 v[194:195], v[194:195], s[74:75], v[110:111] op_sel_hi:[1,0,0]
    v_pk_fma_f32 v[196:197], v[196:197], s[74:75], v[110:111] op_sel_hi:[1,0,0]
    v_pk_fma_f32 v[198:199], v[198:199], s[74:75], v[110:111] op_sel_hi:[1,0,0]
    v_pk_mul_f32 v[192:193], v[192:193], v[28:29]
    v_pk_mul_f32 v[194:195], v[194:195], v[30:31]
    v_pk_mul_f32 v[196:197], v[196:197], v[56:57]
    v_pk_mul_f32 v[198:199], v[198:199], v[58:59]
    v_exp_f32 v192, v192
    v_exp_f32 v193, v193
    v_exp_f32 v194, v194
    v_exp_f32 v195, v195
    v_exp_f32 v196, v196
    v_exp_f32 v197, v197
    v_exp_f32 v198, v198
    v_exp_f32 v199, v199
    v_pk_add_f32 v[192:193], v[192:193], 1.0 op_sel_hi:[1,0]
    v_pk_add_f32 v[194:195], v[194:195], 1.0 op_sel_hi:[1,0]
    v_pk_add_f32 v[196:197], v[196:197], 1.0 op_sel_hi:[1,0]
    v_pk_add_f32 v[198:199], v[198:199], 1.0 op_sel_hi:[1,0]
    v_rcp_f32 v192, v192
    v_rcp_f32 v193, v193
    v_rcp_f32 v194, v194
    v_rcp_f32 v195, v195
    v_rcp_f32 v196, v196
    v_rcp_f32 v197, v197
    v_rcp_f32 v198, v198
    v_rcp_f32 v199, v199
    v_pk_mul_f32 v[28:29], v[28:29], v[192:193]
    v_pk_mul_f32 v[30:31], v[30:31], v[194:195]
    v_pk_mul_f32 v[56:57], v[56:57], v[196:197]
    v_pk_mul_f32 v[58:59], v[58:59], v[198:199]
    v_cvt_pk_bf16_f32 v210, v28, v29
    v_cvt_pk_bf16_f32 v211, v30, v31
    v_cvt_pk_bf16_f32 v214, v56, v57
    v_cvt_pk_bf16_f32 v215, v58, v59
    buffer_store_dwordx4 v[208:211], v12, s[32:35], s60 offen offset:1024 sc1
    buffer_store_dwordx4 v[212:215], v13, s[32:35], s60 offen offset:1024 sc1
    s_waitcnt lgkmcnt(0)
    v_pk_fma_f32 v[192:193], v[176:177], v[122:123], v[180:181] op_sel_hi:[1,0,1]
    v_pk_fma_f32 v[194:195], v[178:179], v[122:123], v[182:183] op_sel_hi:[1,0,1]
    v_pk_fma_f32 v[196:197], v[176:177], v[126:127], v[180:181] op_sel_hi:[1,0,1]
    v_pk_fma_f32 v[198:199], v[178:179], v[126:127], v[182:183] op_sel_hi:[1,0,1]
    v_pk_fma_f32 v[40:41], v[40:41], v[120:121], v[192:193] op_sel_hi:[1,0,1]
    v_pk_fma_f32 v[42:43], v[42:43], v[120:121], v[194:195] op_sel_hi:[1,0,1]
    v_pk_fma_f32 v[68:69], v[68:69], v[124:125], v[196:197] op_sel_hi:[1,0,1]
    v_pk_fma_f32 v[70:71], v[70:71], v[124:125], v[198:199] op_sel_hi:[1,0,1]
    v_pk_mul_f32 v[192:193], v[40:41], v[40:41]
    v_pk_mul_f32 v[194:195], v[42:43], v[42:43]
    v_pk_mul_f32 v[196:197], v[68:69], v[68:69]
    v_pk_mul_f32 v[198:199], v[70:71], v[70:71]
    v_pk_fma_f32 v[192:193], v[192:193], s[74:75], v[110:111] op_sel_hi:[1,0,0]
    v_pk_fma_f32 v[194:195], v[194:195], s[74:75], v[110:111] op_sel_hi:[1,0,0]
    v_pk_fma_f32 v[196:197], v[196:197], s[74:75], v[110:111] op_sel_hi:[1,0,0]
    v_pk_fma_f32 v[198:199], v[198:199], s[74:75], v[110:111] op_sel_hi:[1,0,0]
    v_pk_mul_f32 v[192:193], v[192:193], v[40:41]
    v_pk_mul_f32 v[194:195], v[194:195], v[42:43]
    v_pk_mul_f32 v[196:197], v[196:197], v[68:69]
    v_pk_mul_f32 v[198:199], v[198:199], v[70:71]
    v_exp_f32 v192, v192
    v_exp_f32 v193, v193
    v_exp_f32 v194, v194
    v_exp_f32 v195, v195
    v_exp_f32 v196, v196
    v_exp_f32 v197, v197
    v_exp_f32 v198, v198
    v_exp_f32 v199, v199
    v_pk_add_f32 v[192:193], v[192:193], 1.0 op_sel_hi:[1,0]
    v_pk_add_f32 v[194:195], v[194:195], 1.0 op_sel_hi:[1,0]
    v_pk_add_f32 v[196:197], v[196:197], 1.0 op_sel_hi:[1,0]
    v_pk_add_f32 v[198:199], v[198:199], 1.0 op_sel_hi:[1,0]
    v_rcp_f32 v192, v192
    v_rcp_f32 v193, v193
    v_rcp_f32 v194, v194
    v_rcp_f32 v195, v195
    v_rcp_f32 v196, v196
    v_rcp_f32 v197, v197
    v_rcp_f32 v198, v198
    v_rcp_f32 v199, v199
    v_pk_mul_f32 v[40:41], v[40:41], v[192:193]
    v_pk_mul_f32 v[42:43], v[42:43], v[194:195]
    v_pk_mul_f32 v[68:69], v[68:69], v[196:197]
    v_pk_mul_f32 v[70:71], v[70:71], v[198:199]
    v_cvt_pk_bf16_f32 v216, v40, v41
    v_cvt_pk_bf16_f32 v217, v42, v43
    v_cvt_pk_bf16_f32 v220, v68, v69
    v_cvt_pk_bf16_f32 v221, v70, v71
    buffer_store_dwordx2 v[216:217], v10, s[32:35], s61 offen offset:3072 sc1
    buffer_store_dwordx2 v[220:221], v11, s[32:35], s61 offen offset:3072 sc1
    v_pk_fma_f32 v[192:193], v[160:161], v[122:123], v[164:165] op_sel_hi:[1,0,1]
    v_pk_fma_f32 v[194:195], v[162:163], v[122:123], v[166:167] op_sel_hi:[1,0,1]
    v_pk_fma_f32 v[196:197], v[160:161], v[126:127], v[164:165] op_sel_hi:[1,0,1]
    v_pk_fma_f32 v[198:199], v[162:163], v[126:127], v[166:167] op_sel_hi:[1,0,1]
    v_pk_fma_f32 v[32:33], v[32:33], v[120:121], v[192:193] op_sel_hi:[1,0,1]
    v_pk_fma_f32 v[34:35], v[34:35], v[120:121], v[194:195] op_sel_hi:[1,0,1]
    v_pk_fma_f32 v[60:61], v[60:61], v[124:125], v[196:197] op_sel_hi:[1,0,1]
    v_pk_fma_f32 v[62:63], v[62:63], v[124:125], v[198:199] op_sel_hi:[1,0,1]
    v_pk_mul_f32 v[192:193], v[32:33], v[32:33]
    v_pk_mul_f32 v[194:195], v[34:35], v[34:35]
    v_pk_mul_f32 v[196:197], v[60:61], v[60:61]
    v_pk_mul_f32 v[198:199], v[62:63], v[62:63]
    v_pk_fma_f32 v[192:193], v[192:193], s[74:75], v[110:111] op_sel_hi:[1,0,0]
    v_pk_fma_f32 v[194:195], v[194:195], s[74:75], v[110:111] op_sel_hi:[1,0,0]
    v_pk_fma_f32 v[196:197], v[196:197], s[74:75], v[110:111] op_sel_hi:[1,0,0]
    v_pk_fma_f32 v[198:199], v[198:199], s[74:75], v[110:111] op_sel_hi:[1,0,0]
    v_pk_mul_f32 v[192:193], v[192:193], v[32:33]
    v_pk_mul_f32 v[194:195], v[194:195], v[34:35]
    v_pk_mul_f32 v[196:197], v[196:197], v[60:61]
    v_pk_mul_f32 v[198:199], v[198:199], v[62:63]
    v_exp_f32 v192, v192
    v_exp_f32 v193, v193
    v_exp_f32 v194, v194
    v_exp_f32 v195, v195
    v_exp_f32 v196, v196
    v_exp_f32 v197, v197
    v_exp_f32 v198, v198
    v_exp_f32 v199, v199
    v_pk_add_f32 v[192:193], v[192:193], 1.0 op_sel_hi:[1,0]
    v_pk_add_f32 v[194:195], v[194:195], 1.0 op_sel_hi:[1,0]
    v_pk_add_f32 v[196:197], v[196:197], 1.0 op_sel_hi:[1,0]
    v_pk_add_f32 v[198:199], v[198:199], 1.0 op_sel_hi:[1,0]
    v_rcp_f32 v192, v192
    v_rcp_f32 v193, v193
    v_rcp_f32 v194, v194
    v_rcp_f32 v195, v195
    v_rcp_f32 v196, v196
    v_rcp_f32 v197, v197
    v_rcp_f32 v198, v198
    v_rcp_f32 v199, v199
    v_pk_mul_f32 v[32:33], v[32:33], v[192:193]
    v_pk_mul_f32 v[34:35], v[34:35], v[194:195]
    v_pk_mul_f32 v[60:61], v[60:61], v[196:197]
    v_pk_mul_f32 v[62:63], v[62:63], v[198:199]
    v_cvt_pk_bf16_f32 v200, v32, v33
    v_cvt_pk_bf16_f32 v201, v34, v35
    v_cvt_pk_bf16_f32 v204, v60, v61
    v_cvt_pk_bf16_f32 v205, v62, v63
    v_pk_fma_f32 v[192:193], v[168:169], v[122:123], v[172:173] op_sel_hi:[1,0,1]
    v_pk_fma_f32 v[194:195], v[170:171], v[122:123], v[174:175] op_sel_hi:[1,0,1]
    v_pk_fma_f32 v[196:197], v[168:169], v[126:127], v[172:173] op_sel_hi:[1,0,1]
    v_pk_fma_f32 v[198:199], v[170:171], v[126:127], v[174:175] op_sel_hi:[1,0,1]
    v_pk_fma_f32 v[36:37], v[36:37], v[120:121], v[192:193] op_sel_hi:[1,0,1]
    v_pk_fma_f32 v[38:39], v[38:39], v[120:121], v[194:195] op_sel_hi:[1,0,1]
    v_pk_fma_f32 v[64:65], v[64:65], v[124:125], v[196:197] op_sel_hi:[1,0,1]
    v_pk_fma_f32 v[66:67], v[66:67], v[124:125], v[198:199] op_sel_hi:[1,0,1]
    v_pk_mul_f32 v[192:193], v[36:37], v[36:37]
    v_pk_mul_f32 v[194:195], v[38:39], v[38:39]
    v_pk_mul_f32 v[196:197], v[64:65], v[64:65]
    v_pk_mul_f32 v[198:199], v[66:67], v[66:67]
    v_pk_fma_f32 v[192:193], v[192:193], s[74:75], v[110:111] op_sel_hi:[1,0,0]
    v_pk_fma_f32 v[194:195], v[194:195], s[74:75], v[110:111] op_sel_hi:[1,0,0]
    v_pk_fma_f32 v[196:197], v[196:197], s[74:75], v[110:111] op_sel_hi:[1,0,0]
    v_pk_fma_f32 v[198:199], v[198:199], s[74:75], v[110:111] op_sel_hi:[1,0,0]
    v_pk_mul_f32 v[192:193], v[192:193], v[36:37]
    v_pk_mul_f32 v[194:195], v[194:195], v[38:39]
    v_pk_mul_f32 v[196:197], v[196:197], v[64:65]
    v_pk_mul_f32 v[198:199], v[198:199], v[66:67]
    v_exp_f32 v192, v192
    v_exp_f32 v193, v193
    v_exp_f32 v194, v194
    v_exp_f32 v195, v195
    v_exp_f32 v196, v196
    v_exp_f32 v197, v197
    v_exp_f32 v198, v198
    v_exp_f32 v199, v199
    v_pk_add_f32 v[192:193], v[192:193], 1.0 op_sel_hi:[1,0]
    v_pk_add_f32 v[194:195], v[194:195], 1.0 op_sel_hi:[1,0]
    v_pk_add_f32 v[196:197], v[196:197], 1.0 op_sel_hi:[1,0]
    v_pk_add_f32 v[198:199], v[198:199], 1.0 op_sel_hi:[1,0]
    v_rcp_f32 v192, v192
    v_rcp_f32 v193, v193
    v_rcp_f32 v194, v194
    v_rcp_f32 v195, v195
    v_rcp_f32 v196, v196
    v_rcp_f32 v197, v197
    v_rcp_f32 v198, v198
    v_rcp_f32 v199, v199
    v_pk_mul_f32 v[36:37], v[36:37], v[192:193]
    v_pk_mul_f32 v[38:39], v[38:39], v[194:195]
    v_pk_mul_f32 v[64:65], v[64:65], v[196:197]
    v_pk_mul_f32 v[66:67], v[66:67], v[198:199]
    v_cvt_pk_bf16_f32 v202, v36, v37
    v_cvt_pk_bf16_f32 v203, v38, v39
    v_cvt_pk_bf16_f32 v206, v64, v65
    v_cvt_pk_bf16_f32 v207, v66, v67
    buffer_store_dwordx4 v[200:203], v12, s[32:35], s60 offen offset:2048 sc1
    buffer_store_dwordx4 v[204:207], v13, s[32:35], s60 offen offset:2048 sc1
    s_lshl_b32 s75, s51, 1
    s_add_u32 s75, s75, s53
    s_lshl_b32 s75, s75, 2
    s_mul_i32 s60, s48, 14336
    s_add_u32 s60, s60, 12582912
    s_lshr_b32 s73, s75, 5
    s_mul_i32 s73, s73, 2162688
    s_add_u32 s60, s60, s73
    s_and_b32 s75, s75, 31
    s_add_u32 s73, s48, 1
    s_and_b32 s73, s73, 3
    s_mul_i32 s74, s73, 12288
    s_add_u32 s74, s74, 0
    v_add_u32 v10, s74, v1
    s_add_u32 s73, s73, s75
    s_mul_i32 s73, s73, 57344
    s_add_u32 s73, s73, s60
    v_add_u32 v6, s73, v1
    s_add_u32 s73, s48, 2
    s_and_b32 s73, s73, 3
    s_mul_i32 s74, s73, 12288
    s_add_u32 s74, s74, 4096
    v_add_u32 v11, s74, v1
    s_add_u32 s73, s73, s75
    s_mul_i32 s73, s73, 57344
    s_add_u32 s73, s73, s60
    v_add_u32 v7, s73, v1
    s_add_u32 s73, s48, 3
    s_and_b32 s73, s73, 3
    s_mul_i32 s74, s73, 12288
    s_add_u32 s74, s74, 8192
    v_add_u32 v12, s74, v1
    s_add_u32 s73, s73, s75
    s_mul_i32 s73, s73, 57344
    s_add_u32 s73, s73, s60
    v_add_u32 v8, s73, v1
    s_add_u32 s73, s48, 4
    s_and_b32 s73, s73, 3
    s_add_u32 s73, s73, s75
    s_mul_i32 s73, s73, 57344
    s_add_u32 s73, s73, s60
    v_add_u32 v9, s73, v1
    s_mul_i32 s74, s48, 12288
    s_add_u32 s74, s74, 0
    v_add_u32 v13, s74, v1
    v_lshlrev_b32 v15, 3, v0
    v_sub_u32 v2, v6, v15
    v_sub_u32 v3, v7, v15
    v_sub_u32 v4, v8, v15
    v_sub_u32 v15, v9, v15
    s_lshl_b32 s72, s50, 8
    s_add_u32 s72, s72, 12288
    v_mov_b32 v127, 1
    s_cmp_lg_u32 s48, 0
    s_waitcnt vmcnt(0)
    s_barrier
    s_cbranch_scc1 L_arr_8
    s_mov_b64 exec, 1
    buffer_atomic_add v127, off, s[32:35], s72 sc1
    s_mov_b64 exec, -1
L_arr_8:
    buffer_load_dwordx4 a[192:195], v5, s[32:35], s99 offen sc1
    buffer_load_dwordx4 a[196:199], v5, s[32:35], s99 offen offset:1024 sc1
    buffer_load_dwordx4 a[200:203], v5, s[32:35], s99 offen offset:2048 sc1
    buffer_load_dwordx4 a[204:207], v5, s[32:35], s99 offen offset:3072 sc1
    buffer_load_dwordx4 a[208:211], v5, s[32:35], s100 offen sc1
    buffer_load_dwordx4 a[212:215], v5, s[32:35], s100 offen offset:1024 sc1
    buffer_load_dwordx4 a[216:219], v5, s[32:35], s100 offen offset:2048 sc1
    buffer_load_dwordx4 a[220:223], v5, s[32:35], s100 offen offset:3072 sc1
    s_cmp_lg_u32 s48, 0
    s_cbranch_scc1 L_poll_9_done
    s_lshl_b32 s72, s51, 8
    s_add_u32 s72, s72, 12288
    s_mov_b64 exec, 1
    s_mov_b32 s74, 0
.p2align 6
L_poll_9:
    v_mov_b32 v127, 0
    buffer_atomic_add v127, off, s[32:35], s72 sc0 sc1
    s_add_u32 s74, s74, 1
    s_cmp_ge_u32 s74, 0x80000
    s_cbranch_scc1 L_poll_9_to
    s_waitcnt vmcnt(0)
    v_cmp_gt_u32 vcc, 16, v127
    s_cbranch_vccnz L_poll_9
L_poll_9_to:
    s_waitcnt vmcnt(0)
L_poll_9_out:
    s_mov_b64 exec, -1
L_poll_9_done:
    s_barrier
    buffer_load_dwordx4 v[128:131], v6, s[32:35], 0 offen sc1
    buffer_load_dwordx4 v[132:135], v6, s[32:35], 0 offen offset:1024 sc1
    buffer_load_dwordx4 v[136:139], v6, s[32:35], 0 offen offset:2048 sc1
    buffer_load_dwordx2 v[140:141], v2, s[32:35], 0 offen offset:3072 sc1
    buffer_load_dwordx2 v[142:143], v2, s[32:35], 0 offen offset:3584 sc1
    buffer_load_dwordx4 v[144:147], v6, s[32:35], s62 offen sc1
    buffer_load_dwordx4 v[148:151], v6, s[32:35], s62 offen offset:1024 sc1
    buffer_load_dwordx4 v[152:155], v6, s[32:35], s62 offen offset:2048 sc1
    buffer_load_dwordx4 v[156:159], v6, s[32:35], s62 offen offset:3072 sc1
    buffer_load_dwordx4 v[160:163], v6, s[32:35], s63 offen sc1
    buffer_load_dwordx4 v[164:167], v6, s[32:35], s63 offen offset:1024 sc1
    v_accvgpr_read_b32 v112, a224
    v_accvgpr_read_b32 v113, a225
    v_accvgpr_read_b32 v114, a226
    v_accvgpr_read_b32 v115, a227
    v_accvgpr_read_b32 v116, a228
    v_accvgpr_read_b32 v117, a229
    v_accvgpr_read_b32 v118, a230
    v_accvgpr_read_b32 v119, a231
    v_accvgpr_read_b32 v120, a232
    v_accvgpr_read_b32 v121, a233
    v_accvgpr_read_b32 v122, a234
    v_accvgpr_read_b32 v123, a235
    v_accvgpr_read_b32 v124, a236
    v_accvgpr_read_b32 v125, a237
    v_accvgpr_read_b32 v126, a238
    v_accvgpr_read_b32 v127, a239
    s_waitcnt vmcnt(10)
    v_mfma_f32_16x16x32_bf16 v[16:19], a[0:3], v[128:131], 0
    buffer_load_dwordx2 v[168:169], v2, s[32:35], s63 offen offset:2048 sc1
    buffer_load_dwordx2 v[170:171], v2, s[32:35], s63 offen offset:2560 sc1
    v_mfma_f32_16x16x32_bf16 v[20:23], a[4:7], v[128:131], 0
    v_mfma_f32_16x16x32_bf16 v[24:27], a[8:11], v[128:131], 0
    v_mfma_f32_16x16x32_bf16 v[28:31], a[12:15], v[128:131], 0
    s_waitcnt vmcnt(11)
    v_mfma_f32_16x16x32_bf16 v[16:19], a[16:19], v[132:135], v[16:19]
    buffer_load_dwordx4 v[172:175], v6, s[32:35], s63 offen offset:3072 sc1
    v_mfma_f32_16x16x32_bf16 v[20:23], a[20:23], v[132:135], v[20:23]
    v_mfma_f32_16x16x32_bf16 v[24:27], a[24:27], v[132:135], v[24:27]
    v_mfma_f32_16x16x32_bf16 v[28:31], a[28:31], v[132:135], v[28:31]
    s_waitcnt vmcnt(11)
    v_mfma_f32_16x16x32_bf16 v[16:19], a[32:35], v[136:139], v[16:19]
    buffer_load_dwordx4 v[176:179], v6, s[32:35], s64 offen sc1
    v_mfma_f32_16x16x32_bf16 v[20:23], a[36:39], v[136:139], v[20:23]
    v_mfma_f32_16x16x32_bf16 v[24:27], a[40:43], v[136:139], v[24:27]
    v_mfma_f32_16x16x32_bf16 v[28:31], a[44:47], v[136:139], v[28:31]
    s_waitcnt vmcnt(10)
    v_mfma_f32_16x16x32_bf16 v[16:19], a[48:51], v[140:143], v[16:19]
    buffer_load_dwordx4 v[180:183], v6, s[32:35], s64 offen offset:1024 sc1
    v_mfma_f32_16x16x32_bf16 v[20:23], a[52:55], v[140:143], v[20:23]
    v_mfma_f32_16x16x32_bf16 v[24:27], a[56:59], v[140:143], v[24:27]
    v_mfma_f32_16x16x32_bf16 v[28:31], a[60:63], v[140:143], v[28:31]
    s_waitcnt vmcnt(10)
    v_mfma_f32_16x16x32_bf16 v[16:19], a[64:67], v[144:147], v[16:19]
    buffer_load_dwordx4 v[184:187], v7, s[32:35], 0 offen sc1
    v_mfma_f32_16x16x32_bf16 v[20:23], a[68:71], v[144:147], v[20:23]
    v_mfma_f32_16x16x32_bf16 v[24:27], a[72:75], v[144:147], v[24:27]
    v_mfma_f32_16x16x32_bf16 v[28:31], a[76:79], v[144:147], v[28:31]
    s_waitcnt vmcnt(10)
    v_mfma_f32_16x16x32_bf16 v[16:19], a[80:83], v[148:151], v[16:19]
    buffer_load_dwordx4 v[188:191], v7, s[32:35], 0 offen offset:1024 sc1
    v_mfma_f32_16x16x32_bf16 v[20:23], a[84:87], v[148:151], v[20:23]
    v_mfma_f32_16x16x32_bf16 v[24:27], a[88:91], v[148:151], v[24:27]
    v_mfma_f32_16x16x32_bf16 v[28:31], a[92:95], v[148:151], v[28:31]
    s_waitcnt vmcnt(10)
    v_mfma_f32_16x16x32_bf16 v[16:19], a[96:99], v[152:155], v[16:19]
    buffer_load_dwordx4 v[192:195], v7, s[32:35], 0 offen offset:2048 sc1
    v_mfma_f32_16x16x32_bf16 v[20:23], a[100:103], v[152:155], v[20:23]
    v_mfma_f32_16x16x32_bf16 v[24:27], a[104:107], v[152:155], v[24:27]
    v_mfma_f32_16x16x32_bf16 v[28:31], a[108:111], v[152:155], v[28:31]
    s_waitcnt vmcnt(10)
    v_mfma_f32_16x16x32_bf16 v[16:19], a[112:115], v[156:159], v[16:19]
    buffer_load_dwordx2 v[196:197], v3, s[32:35], 0 offen offset:3072 sc1
    buffer_load_dwordx2 v[198:199], v3, s[32:35], 0 offen offset:3584 sc1
    v_mfma_f32_16x16x32_bf16 v[20:23], a[116:119], v[156:159], v[20:23]
    v_mfma_f32_16x16x32_bf16 v[24:27], a[120:123], v[156:159], v[24:27]
    v_mfma_f32_16x16x32_bf16 v[28:31], a[124:127], v[156:159], v[28:31]
    s_waitcnt vmcnt(11)
    v_mfma_f32_16x16x32_bf16 v[16:19], a[128:131], v[160:163], v[16:19]
    buffer_load_dwordx4 v[200:203], v7, s[32:35], s62 offen sc1
    v_mfma_f32_16x16x32_bf16 v[20:23], a[132:135], v[160:163], v[20:23]
    v_mfma_f32_16x16x32_bf16 v[24:27], a[136:139], v[160:163], v[24:27]
    v_mfma_f32_16x16x32_bf16 v[28:31], a[140:143], v[160:163], v[28:31]
    s_waitcnt vmcnt(11)
    v_mfma_f32_16x16x32_bf16 v[16:19], a[144:147], v[164:167], v[16:19]
    buffer_load_dwordx4 v[204:207], v7, s[32:35], s62 offen offset:1024 sc1
    v_mfma_f32_16x16x32_bf16 v[20:23], a[148:151], v[164:167], v[20:23]
    v_mfma_f32_16x16x32_bf16 v[24:27], a[152:155], v[164:167], v[24:27]
    v_mfma_f32_16x16x32_bf16 v[28:31], a[156:159], v[164:167], v[28:31]
    s_waitcnt vmcnt(10)
    v_mfma_f32_16x16x32_bf16 v[16:19], a[160:163], v[168:171], v[16:19]
    buffer_load_dwordx4 v[208:211], v7, s[32:35], s62 offen offset:2048 sc1
    v_mfma_f32_16x16x32_bf16 v[20:23], a[164:167], v[168:171], v[20:23]
    v_mfma_f32_16x16x32_bf16 v[24:27], a[168:171], v[168:171], v[24:27]
    v_mfma_f32_16x16x32_bf16 v[28:31], a[172:175], v[168:171], v[28:31]
    s_waitcnt vmcnt(10)
    v_mfma_f32_16x16x32_bf16 v[16:19], a[176:179], v[172:175], v[16:19]
    buffer_load_dwordx4 v[212:215], v7, s[32:35], s62 offen offset:3072 sc1
    v_mfma_f32_16x16x32_bf16 v[20:23], a[180:183], v[172:175], v[20:23]
    v_mfma_f32_16x16x32_bf16 v[24:27], a[184:187], v[172:175], v[24:27]
    v_mfma_f32_16x16x32_bf16 v[28:31], a[188:191], v[172:175], v[28:31]
    s_waitcnt vmcnt(10)
    v_mfma_f32_16x16x32_bf16 v[16:19], a[192:195], v[176:179], v[16:19]
    buffer_load_dwordx4 v[216:219], v7, s[32:35], s63 offen sc1
    v_mfma_f32_16x16x32_bf16 v[20:23], a[196:199], v[176:179], v[20:23]
    v_mfma_f32_16x16x32_bf16 v[24:27], a[200:203], v[176:179], v[24:27]
    v_mfma_f32_16x16x32_bf16 v[28:31], a[204:207], v[176:179], v[28:31]
    s_waitcnt vmcnt(10)
    v_mfma_f32_16x16x32_bf16 v[16:19], a[208:211], v[180:183], v[16:19]
    buffer_load_dwordx4 v[220:223], v7, s[32:35], s63 offen offset:1024 sc1
    v_mfma_f32_16x16x32_bf16 v[20:23], a[212:215], v[180:183], v[20:23]
    v_mfma_f32_16x16x32_bf16 v[24:27], a[216:219], v[180:183], v[24:27]
    v_mfma_f32_16x16x32_bf16 v[28:31], a[220:223], v[180:183], v[28:31]
    s_waitcnt vmcnt(10)
    v_mfma_f32_16x16x32_bf16 v[32:35], a[0:3], v[184:187], 0
    buffer_load_dwordx2 v[224:225], v3, s[32:35], s63 offen offset:2048 sc1
    buffer_load_dwordx2 v[226:227], v3, s[32:35], s63 offen offset:2560 sc1
    v_mfma_f32_16x16x32_bf16 v[36:39], a[4:7], v[184:187], 0
    v_mfma_f32_16x16x32_bf16 v[40:43], a[8:11], v[184:187], 0
    v_mfma_f32_16x16x32_bf16 v[44:47], a[12:15], v[184:187], 0
    s_waitcnt vmcnt(11)
    v_mfma_f32_16x16x32_bf16 v[32:35], a[16:19], v[188:191], v[32:35]
    buffer_load_dwordx4 v[228:231], v7, s[32:35], s63 offen offset:3072 sc1
    v_mfma_f32_16x16x32_bf16 v[36:39], a[20:23], v[188:191], v[36:39]
    ds_write_b128 v10, v[16:19]
    v_mfma_f32_16x16x32_bf16 v[40:43], a[24:27], v[188:191], v[40:43]
    v_mfma_f32_16x16x32_bf16 v[44:47], a[28:31], v[188:191], v[44:47]
    s_waitcnt vmcnt(11)
    v_mfma_f32_16x16x32_bf16 v[32:35], a[32:35], v[192:195], v[32:35]
    buffer_load_dwordx4 v[232:235], v7, s[32:35], s64 offen sc1
    v_mfma_f32_16x16x32_bf16 v[36:39], a[36:39], v[192:195], v[36:39]
    ds_write_b128 v10, v[20:23] offset:1024
    v_mfma_f32_16x16x32_bf16 v[40:43], a[40:43], v[192:195], v[40:43]
    v_mfma_f32_16x16x32_bf16 v[44:47], a[44:47], v[192:195], v[44:47]
    s_waitcnt vmcnt(10)
    v_mfma_f32_16x16x32_bf16 v[32:35], a[48:51], v[196:199], v[32:35]
    buffer_load_dwordx4 v[236:239], v7, s[32:35], s64 offen offset:1024 sc1
    v_mfma_f32_16x16x32_bf16 v[36:39], a[52:55], v[196:199], v[36:39]
    ds_write_b128 v10, v[24:27] offset:2048
    v_mfma_f32_16x16x32_bf16 v[40:43], a[56:59], v[196:199], v[40:43]
    v_mfma_f32_16x16x32_bf16 v[44:47], a[60:63], v[196:199], v[44:47]
    s_waitcnt vmcnt(10)
    v_mfma_f32_16x16x32_bf16 v[32:35], a[64:67], v[200:203], v[32:35]
    buffer_load_dwordx4 v[128:131], v8, s[32:35], 0 offen sc1
    v_mfma_f32_16x16x32_bf16 v[36:39], a[68:71], v[200:203], v[36:39]
    ds_write_b128 v10, v[28:31] offset:3072
    v_mfma_f32_16x16x32_bf16 v[40:43], a[72:75], v[200:203], v[40:43]
    v_mfma_f32_16x16x32_bf16 v[44:47], a[76:79], v[200:203], v[44:47]
    s_waitcnt vmcnt(10)
    v_mfma_f32_16x16x32_bf16 v[32:35], a[80:83], v[204:207], v[32:35]
    buffer_load_dwordx4 v[132:135], v8, s[32:35], 0 offen offset:1024 sc1
    v_mfma_f32_16x16x32_bf16 v[36:39], a[84:87], v[204:207], v[36:39]
    v_mfma_f32_16x16x32_bf16 v[40:43], a[88:91], v[204:207], v[40:43]
    v_mfma_f32_16x16x32_bf16 v[44:47], a[92:95], v[204:207], v[44:47]
    s_waitcnt vmcnt(10)
    v_mfma_f32_16x16x32_bf16 v[32:35], a[96:99], v[208:211], v[32:35]
    buffer_load_dwordx4 v[136:139], v8, s[32:35], 0 offen offset:2048 sc1
    v_mfma_f32_16x16x32_bf16 v[36:39], a[100:103], v[208:211], v[36:39]
    v_mfma_f32_16x16x32_bf16 v[40:43], a[104:107], v[208:211], v[40:43]
    v_mfma_f32_16x16x32_bf16 v[44:47], a[108:111], v[208:211], v[44:47]
    s_waitcnt vmcnt(10)
    v_mfma_f32_16x16x32_bf16 v[32:35], a[112:115], v[212:215], v[32:35]
    buffer_load_dwordx2 v[140:141], v4, s[32:35], 0 offen offset:3072 sc1
    buffer_load_dwordx2 v[142:143], v4, s[32:35], 0 offen offset:3584 sc1
    v_mfma_f32_16x16x32_bf16 v[36:39], a[116:119], v[212:215], v[36:39]
    v_mfma_f32_16x16x32_bf16 v[40:43], a[120:123], v[212:215], v[40:43]
    v_mfma_f32_16x16x32_bf16 v[44:47], a[124:127], v[212:215], v[44:47]
    s_waitcnt vmcnt(11)
    v_mfma_f32_16x16x32_bf16 v[32:35], a[128:131], v[216:219], v[32:35]
    buffer_load_dwordx4 v[144:147], v8, s[32:35], s62 offen sc1
    v_mfma_f32_16x16x32_bf16 v[36:39], a[132:135], v[216:219], v[36:39]
    v_mfma_f32_16x16x32_bf16 v[40:43], a[136:139], v[216:219], v[40:43]
    v_mfma_f32_16x16x32_bf16 v[44:47], a[140:143], v[216:219], v[44:47]
    s_waitcnt vmcnt(11)
    v_mfma_f32_16x16x32_bf16 v[32:35], a[144:147], v[220:223], v[32:35]
    buffer_load_dwordx4 v[148:151], v8, s[32:35], s62 offen offset:1024 sc1
    v_mfma_f32_16x16x32_bf16 v[36:39], a[148:151], v[220:223], v[36:39]
    v_mfma_f32_16x16x32_bf16 v[40:43], a[152:155], v[220:223], v[40:43]
    v_mfma_f32_16x16x32_bf16 v[44:47], a[156:159], v[220:223], v[44:47]
    s_waitcnt vmcnt(10)
    v_mfma_f32_16x16x32_bf16 v[32:35], a[160:163], v[224:227], v[32:35]
    buffer_load_dwordx4 v[152:155], v8, s[32:35], s62 offen offset:2048 sc1
    v_mfma_f32_16x16x32_bf16 v[36:39], a[164:167], v[224:227], v[36:39]
    v_mfma_f32_16x16x32_bf16 v[40:43], a[168:171], v[224:227], v[40:43]
    v_mfma_f32_16x16x32_bf16 v[44:47], a[172:175], v[224:227], v[44:47]
    s_waitcnt vmcnt(10)
    v_mfma_f32_16x16x32_bf16 v[32:35], a[176:179], v[228:231], v[32:35]
    buffer_load_dwordx4 v[156:159], v8, s[32:35], s62 offen offset:3072 sc1
    v_mfma_f32_16x16x32_bf16 v[36:39], a[180:183], v[228:231], v[36:39]
    v_mfma_f32_16x16x32_bf16 v[40:43], a[184:187], v[228:231], v[40:43]
    v_mfma_f32_16x16x32_bf16 v[44:47], a[188:191], v[228:231], v[44:47]
    s_waitcnt vmcnt(10)
    v_mfma_f32_16x16x32_bf16 v[32:35], a[192:195], v[232:235], v[32:35]
    buffer_load_dwordx4 v[160:163], v8, s[32:35], s63 offen sc1
    v_mfma_f32_16x16x32_bf16 v[36:39], a[196:199], v[232:235], v[36:39]
    v_mfma_f32_16x16x32_bf16 v[40:43], a[200:203], v[232:235], v[40:43]
    v_mfma_f32_16x16x32_bf16 v[44:47], a[204:207], v[232:235], v[44:47]
    s_waitcnt vmcnt(10)
    v_mfma_f32_16x16x32_bf16 v[32:35], a[208:211], v[236:239], v[32:35]
    buffer_load_dwordx4 v[164:167], v8, s[32:35], s63 offen offset:1024 sc1
    v_mfma_f32_16x16x32_bf16 v[36:39], a[212:215], v[236:239], v[36:39]
    v_mfma_f32_16x16x32_bf16 v[40:43], a[216:219], v[236:239], v[40:43]
    v_mfma_f32_16x16x32_bf16 v[44:47], a[220:223], v[236:239], v[44:47]
    s_waitcnt vmcnt(10)
    v_mfma_f32_16x16x32_bf16 v[48:51], a[0:3], v[128:131], 0
    buffer_load_dwordx2 v[168:169], v4, s[32:35], s63 offen offset:2048 sc1
    buffer_load_dwordx2 v[170:171], v4, s[32:35], s63 offen offset:2560 sc1
    v_mfma_f32_16x16x32_bf16 v[52:55], a[4:7], v[128:131], 0
    v_mfma_f32_16x16x32_bf16 v[56:59], a[8:11], v[128:131], 0
    v_mfma_f32_16x16x32_bf16 v[60:63], a[12:15], v[128:131], 0
    s_waitcnt vmcnt(11)
    v_mfma_f32_16x16x32_bf16 v[48:51], a[16:19], v[132:135], v[48:51]
    buffer_load_dwordx4 v[172:175], v8, s[32:35], s63 offen offset:3072 sc1
    v_mfma_f32_16x16x32_bf16 v[52:55], a[20:23], v[132:135], v[52:55]
    ds_write_b128 v11, v[32:35]
    v_mfma_f32_16x16x32_bf16 v[56:59], a[24:27], v[132:135], v[56:59]
    v_mfma_f32_16x16x32_bf16 v[60:63], a[28:31], v[132:135], v[60:63]
    s_waitcnt vmcnt(11)
    v_mfma_f32_16x16x32_bf16 v[48:51], a[32:35], v[136:139], v[48:51]
    buffer_load_dwordx4 v[176:179], v8, s[32:35], s64 offen sc1
    v_mfma_f32_16x16x32_bf16 v[52:55], a[36:39], v[136:139], v[52:55]
    ds_write_b128 v11, v[36:39] offset:1024
    v_mfma_f32_16x16x32_bf16 v[56:59], a[40:43], v[136:139], v[56:59]
    v_mfma_f32_16x16x32_bf16 v[60:63], a[44:47], v[136:139], v[60:63]
    s_waitcnt vmcnt(10)
    v_mfma_f32_16x16x32_bf16 v[48:51], a[48:51], v[140:143], v[48:51]
    buffer_load_dwordx4 v[180:183], v8, s[32:35], s64 offen offset:1024 sc1
    v_mfma_f32_16x16x32_bf16 v[52:55], a[52:55], v[140:143], v[52:55]
    ds_write_b128 v11, v[40:43] offset:2048
    v_mfma_f32_16x16x32_bf16 v[56:59], a[56:59], v[140:143], v[56:59]
    v_mfma_f32_16x16x32_bf16 v[60:63], a[60:63], v[140:143], v[60:63]
    s_waitcnt vmcnt(10)
    v_mfma_f32_16x16x32_bf16 v[48:51], a[64:67], v[144:147], v[48:51]
    buffer_load_dwordx4 v[184:187], v9, s[32:35], 0 offen sc1
    v_mfma_f32_16x16x32_bf16 v[52:55], a[68:71], v[144:147], v[52:55]
    ds_write_b128 v11, v[44:47] offset:3072
    v_mfma_f32_16x16x32_bf16 v[56:59], a[72:75], v[144:147], v[56:59]
    v_mfma_f32_16x16x32_bf16 v[60:63], a[76:79], v[144:147], v[60:63]
    s_waitcnt vmcnt(10)
    v_mfma_f32_16x16x32_bf16 v[48:51], a[80:83], v[148:151], v[48:51]
    buffer_load_dwordx4 v[188:191], v9, s[32:35], 0 offen offset:1024 sc1
    v_mfma_f32_16x16x32_bf16 v[52:55], a[84:87], v[148:151], v[52:55]
    v_mfma_f32_16x16x32_bf16 v[56:59], a[88:91], v[148:151], v[56:59]
    v_mfma_f32_16x16x32_bf16 v[60:63], a[92:95], v[148:151], v[60:63]
    s_waitcnt vmcnt(10)
    v_mfma_f32_16x16x32_bf16 v[48:51], a[96:99], v[152:155], v[48:51]
    buffer_load_dwordx4 v[192:195], v9, s[32:35], 0 offen offset:2048 sc1
    v_mfma_f32_16x16x32_bf16 v[52:55], a[100:103], v[152:155], v[52:55]
    v_mfma_f32_16x16x32_bf16 v[56:59], a[104:107], v[152:155], v[56:59]
    v_mfma_f32_16x16x32_bf16 v[60:63], a[108:111], v[152:155], v[60:63]
    s_waitcnt vmcnt(10)
    v_mfma_f32_16x16x32_bf16 v[48:51], a[112:115], v[156:159], v[48:51]
    buffer_load_dwordx2 v[196:197], v15, s[32:35], 0 offen offset:3072 sc1
    buffer_load_dwordx2 v[198:199], v15, s[32:35], 0 offen offset:3584 sc1
    v_mfma_f32_16x16x32_bf16 v[52:55], a[116:119], v[156:159], v[52:55]
    v_mfma_f32_16x16x32_bf16 v[56:59], a[120:123], v[156:159], v[56:59]
    v_mfma_f32_16x16x32_bf16 v[60:63], a[124:127], v[156:159], v[60:63]
    s_waitcnt vmcnt(11)
    v_mfma_f32_16x16x32_bf16 v[48:51], a[128:131], v[160:163], v[48:51]
    buffer_load_dwordx4 v[200:203], v9, s[32:35], s62 offen sc1
    v_mfma_f32_16x16x32_bf16 v[52:55], a[132:135], v[160:163], v[52:55]
    v_mfma_f32_16x16x32_bf16 v[56:59], a[136:139], v[160:163], v[56:59]
    v_mfma_f32_16x16x32_bf16 v[60:63], a[140:143], v[160:163], v[60:63]
    s_waitcnt vmcnt(11)
    v_mfma_f32_16x16x32_bf16 v[48:51], a[144:147], v[164:167], v[48:51]
    buffer_load_dwordx4 v[204:207], v9, s[32:35], s62 offen offset:1024 sc1
    v_mfma_f32_16x16x32_bf16 v[52:55], a[148:151], v[164:167], v[52:55]
    v_mfma_f32_16x16x32_bf16 v[56:59], a[152:155], v[164:167], v[56:59]
    v_mfma_f32_16x16x32_bf16 v[60:63], a[156:159], v[164:167], v[60:63]
    s_waitcnt vmcnt(10)
    v_mfma_f32_16x16x32_bf16 v[48:51], a[160:163], v[168:171], v[48:51]
    buffer_load_dwordx4 v[208:211], v9, s[32:35], s62 offen offset:2048 sc1
    v_mfma_f32_16x16x32_bf16 v[52:55], a[164:167], v[168:171], v[52:55]
    v_mfma_f32_16x16x32_bf16 v[56:59], a[168:171], v[168:171], v[56:59]
    v_mfma_f32_16x16x32_bf16 v[60:63], a[172:175], v[168:171], v[60:63]
    s_waitcnt vmcnt(10)
    v_mfma_f32_16x16x32_bf16 v[48:51], a[176:179], v[172:175], v[48:51]
    buffer_load_dwordx4 v[212:215], v9, s[32:35], s62 offen offset:3072 sc1
    v_mfma_f32_16x16x32_bf16 v[52:55], a[180:183], v[172:175], v[52:55]
    v_mfma_f32_16x16x32_bf16 v[56:59], a[184:187], v[172:175], v[56:59]
    v_mfma_f32_16x16x32_bf16 v[60:63], a[188:191], v[172:175], v[60:63]
    s_waitcnt vmcnt(10)
    v_mfma_f32_16x16x32_bf16 v[48:51], a[192:195], v[176:179], v[48:51]
    buffer_load_dwordx4 v[216:219], v9, s[32:35], s63 offen sc1
    v_mfma_f32_16x16x32_bf16 v[52:55], a[196:199], v[176:179], v[52:55]
    v_mfma_f32_16x16x32_bf16 v[56:59], a[200:203], v[176:179], v[56:59]
    v_mfma_f32_16x16x32_bf16 v[60:63], a[204:207], v[176:179], v[60:63]
    s_waitcnt vmcnt(10)
    v_mfma_f32_16x16x32_bf16 v[48:51], a[208:211], v[180:183], v[48:51]
    buffer_load_dwordx4 v[220:223], v9, s[32:35], s63 offen offset:1024 sc1
    v_mfma_f32_16x16x32_bf16 v[52:55], a[212:215], v[180:183], v[52:55]
    v_mfma_f32_16x16x32_bf16 v[56:59], a[216:219], v[180:183], v[56:59]
    v_mfma_f32_16x16x32_bf16 v[60:63], a[220:223], v[180:183], v[60:63]
    s_waitcnt vmcnt(10)
    v_mfma_f32_16x16x32_bf16 v[112:115], a[0:3], v[184:187], v[112:115]
    buffer_load_dwordx2 v[224:225], v15, s[32:35], s63 offen offset:2048 sc1
    buffer_load_dwordx2 v[226:227], v15, s[32:35], s63 offen offset:2560 sc1
    v_mfma_f32_16x16x32_bf16 v[116:119], a[4:7], v[184:187], v[116:119]
    v_mfma_f32_16x16x32_bf16 v[120:123], a[8:11], v[184:187], v[120:123]
    v_mfma_f32_16x16x32_bf16 v[124:127], a[12:15], v[184:187], v[124:127]
    s_waitcnt vmcnt(11)
    v_mfma_f32_16x16x32_bf16 v[112:115], a[16:19], v[188:191], v[112:115]
    buffer_load_dwordx4 v[228:231], v9, s[32:35], s63 offen offset:3072 sc1
    v_mfma_f32_16x16x32_bf16 v[116:119], a[20:23], v[188:191], v[116:119]
    ds_write_b128 v12, v[48:51]
    v_mfma_f32_16x16x32_bf16 v[120:123], a[24:27], v[188:191], v[120:123]
    v_mfma_f32_16x16x32_bf16 v[124:127], a[28:31], v[188:191], v[124:127]
    s_waitcnt vmcnt(11)
    v_mfma_f32_16x16x32_bf16 v[112:115], a[32:35], v[192:195], v[112:115]
    buffer_load_dwordx4 v[232:235], v9, s[32:35], s64 offen sc1
    v_mfma_f32_16x16x32_bf16 v[116:119], a[36:39], v[192:195], v[116:119]
    ds_write_b128 v12, v[52:55] offset:1024
    v_mfma_f32_16x16x32_bf16 v[120:123], a[40:43], v[192:195], v[120:123]
    v_mfma_f32_16x16x32_bf16 v[124:127], a[44:47], v[192:195], v[124:127]
    s_waitcnt vmcnt(10)
    v_mfma_f32_16x16x32_bf16 v[112:115], a[48:51], v[196:199], v[112:115]
    buffer_load_dwordx4 v[236:239], v9, s[32:35], s64 offen offset:1024 sc1
    v_mfma_f32_16x16x32_bf16 v[116:119], a[52:55], v[196:199], v[116:119]
    ds_write_b128 v12, v[56:59] offset:2048
    v_mfma_f32_16x16x32_bf16 v[120:123], a[56:59], v[196:199], v[120:123]
    v_mfma_f32_16x16x32_bf16 v[124:127], a[60:63], v[196:199], v[124:127]
    s_waitcnt vmcnt(10)
    v_mfma_f32_16x16x32_bf16 v[112:115], a[64:67], v[200:203], v[112:115]
    v_mfma_f32_16x16x32_bf16 v[116:119], a[68:71], v[200:203], v[116:119]
    ds_write_b128 v12, v[60:63] offset:3072
    v_mfma_f32_16x16x32_bf16 v[120:123], a[72:75], v[200:203], v[120:123]
    v_mfma_f32_16x16x32_bf16 v[124:127], a[76:79], v[200:203], v[124:127]
    s_waitcnt vmcnt(9)
    v_mfma_f32_16x16x32_bf16 v[112:115], a[80:83], v[204:207], v[112:115]
    v_mfma_f32_16x16x32_bf16 v[116:119], a[84:87], v[204:207], v[116:119]
    s_waitcnt lgkmcnt(0)
    s_barrier
    v_mfma_f32_16x16x32_bf16 v[120:123], a[88:91], v[204:207], v[120:123]
    v_mfma_f32_16x16x32_bf16 v[124:127], a[92:95], v[204:207], v[124:127]
    s_waitcnt vmcnt(8)
    v_mfma_f32_16x16x32_bf16 v[112:115], a[96:99], v[208:211], v[112:115]
    ds_read_b128 v[64:67], v13
    v_mfma_f32_16x16x32_bf16 v[116:119], a[100:103], v[208:211], v[116:119]
    ds_read_b128 v[68:71], v13 offset:1024
    v_mfma_f32_16x16x32_bf16 v[120:123], a[104:107], v[208:211], v[120:123]
    ds_read_b128 v[72:75], v13 offset:2048
    v_mfma_f32_16x16x32_bf16 v[124:127], a[108:111], v[208:211], v[124:127]
    ds_read_b128 v[76:79], v13 offset:3072
    s_waitcnt vmcnt(7)
    v_mfma_f32_16x16x32_bf16 v[112:115], a[112:115], v[212:215], v[112:115]
    ds_read_b128 v[80:83], v13 offset:4096
    v_mfma_f32_16x16x32_bf16 v[116:119], a[116:119], v[212:215], v[116:119]
    ds_read_b128 v[84:87], v13 offset:5120
    v_mfma_f32_16x16x32_bf16 v[120:123], a[120:123], v[212:215], v[120:123]
    ds_read_b128 v[88:91], v13 offset:6144
    v_mfma_f32_16x16x32_bf16 v[124:127], a[124:127], v[212:215], v[124:127]
    ds_read_b128 v[92:95], v13 offset:7168
    s_waitcnt vmcnt(6)
    v_mfma_f32_16x16x32_bf16 v[112:115], a[128:131], v[216:219], v[112:115]
    ds_read_b128 v[96:99], v13 offset:8192
    v_mfma_f32_16x16x32_bf16 v[116:119], a[132:135], v[216:219], v[116:119]
    ds_read_b128 v[100:103], v13 offset:9216
    v_mfma_f32_16x16x32_bf16 v[120:123], a[136:139], v[216:219], v[120:123]
    ds_read_b128 v[104:107], v13 offset:10240
    v_mfma_f32_16x16x32_bf16 v[124:127], a[140:143], v[216:219], v[124:127]
    ds_read_b128 v[108:111], v13 offset:11264
    s_waitcnt vmcnt(5)
    v_mfma_f32_16x16x32_bf16 v[112:115], a[144:147], v[220:223], v[112:115]
    s_waitcnt lgkmcnt(4)
    v_add_f32 v64, v64, v80
    v_add_f32 v65, v65, v81
    v_mfma_f32_16x16x32_bf16 v[116:119], a[148:151], v[220:223], v[116:119]
    v_add_f32 v66, v66, v82
    v_add_f32 v67, v67, v83
    v_mfma_f32_16x16x32_bf16 v[120:123], a[152:155], v[220:223], v[120:123]
    v_add_f32 v68, v68, v84
    v_add_f32 v69, v69, v85
    v_mfma_f32_16x16x32_bf16 v[124:127], a[156:159], v[220:223], v[124:127]
    v_add_f32 v70, v70, v86
    v_add_f32 v71, v71, v87
    s_waitcnt vmcnt(3)
    v_mfma_f32_16x16x32_bf16 v[112:115], a[160:163], v[224:227], v[112:115]
    v_add_f32 v72, v72, v88
    v_add_f32 v73, v73, v89
    v_mfma_f32_16x16x32_bf16 v[116:119], a[164:167], v[224:227], v[116:119]
    v_add_f32 v74, v74, v90
    v_add_f32 v75, v75, v91
    v_mfma_f32_16x16x32_bf16 v[120:123], a[168:171], v[224:227], v[120:123]
    v_add_f32 v76, v76, v92
    v_add_f32 v77, v77, v93
    v_mfma_f32_16x16x32_bf16 v[124:127], a[172:175], v[224:227], v[124:127]
    v_add_f32 v78, v78, v94
    v_add_f32 v79, v79, v95
    s_waitcnt vmcnt(2)
    v_mfma_f32_16x16x32_bf16 v[112:115], a[176:179], v[228:231], v[112:115]
    s_waitcnt lgkmcnt(0)
    v_add_f32 v64, v64, v96
    v_add_f32 v65, v65, v97
    v_mfma_f32_16x16x32_bf16 v[116:119], a[180:183], v[228:231], v[116:119]
    v_add_f32 v66, v66, v98
    v_add_f32 v67, v67, v99
    v_mfma_f32_16x16x32_bf16 v[120:123], a[184:187], v[228:231], v[120:123]
    v_add_f32 v68, v68, v100
    v_add_f32 v69, v69, v101
    v_mfma_f32_16x16x32_bf16 v[124:127], a[188:191], v[228:231], v[124:127]
    v_add_f32 v70, v70, v102
    v_add_f32 v71, v71, v103
    s_waitcnt vmcnt(1)
    v_mfma_f32_16x16x32_bf16 v[112:115], a[192:195], v[232:235], v[112:115]
    v_add_f32 v72, v72, v104
    v_add_f32 v73, v73, v105
    v_mfma_f32_16x16x32_bf16 v[116:119], a[196:199], v[232:235], v[116:119]
    v_add_f32 v74, v74, v106
    v_add_f32 v75, v75, v107
    v_mfma_f32_16x16x32_bf16 v[120:123], a[200:203], v[232:235], v[120:123]
    v_add_f32 v76, v76, v108
    v_add_f32 v77, v77, v109
    v_mfma_f32_16x16x32_bf16 v[124:127], a[204:207], v[232:235], v[124:127]
    v_add_f32 v78, v78, v110
    v_add_f32 v79, v79, v111
    s_waitcnt vmcnt(0)
    v_mfma_f32_16x16x32_bf16 v[112:115], a[208:211], v[236:239], v[112:115]
    v_mfma_f32_16x16x32_bf16 v[116:119], a[212:215], v[236:239], v[116:119]
    v_mfma_f32_16x16x32_bf16 v[120:123], a[216:219], v[236:239], v[120:123]
    v_mfma_f32_16x16x32_bf16 v[124:127], a[220:223], v[236:239], v[124:127]
    s_nop 4
    v_add_f32 v64, v64, v112
    v_add_f32 v65, v65, v113
    v_add_f32 v66, v66, v114
    v_add_f32 v67, v67, v115
    v_add_f32 v68, v68, v116
    v_add_f32 v69, v69, v117
    v_add_f32 v70, v70, v118
    v_add_f32 v71, v71, v119
    v_cvt_pk_bf16_f32 v32, v64, v65
    v_cvt_pk_bf16_f32 v33, v66, v67
    v_cvt_pk_bf16_f32 v34, v68, v69
    v_cvt_pk_bf16_f32 v35, v70, v71
    s_nop 0
    v_permlane16_swap_b32 v32, v34
    v_permlane16_swap_b32 v33, v35
    buffer_store_dwordx4 v[32:35], v14, s[28:31], s59 offen
    v_pk_add_f32 v[72:73], v[72:73], v[120:121]
    v_pk_add_f32 v[74:75], v[74:75], v[122:123]
    v_pk_add_f32 v[76:77], v[76:77], v[124:125]
    v_pk_add_f32 v[78:79], v[78:79], v[126:127]
    v_cvt_pk_bf16_f32 v36, v72, v73
    v_cvt_pk_bf16_f32 v37, v74, v75
    v_cvt_pk_bf16_f32 v38, v76, v77
    v_cvt_pk_bf16_f32 v39, v78, v79
    s_nop 0
    v_permlane16_swap_b32 v36, v38
    v_permlane16_swap_b32 v37, v39
    buffer_store_dwordx4 v[36:39], v14, s[28:31], s59 offen offset:64
L_end:
    s_endpgm
.section .rodata,"a"
.p2align 6
.amdhsa_kernel sequential_preLN__linear_kernel_hedgehog__dense_activation_gelu__prompt_kernel
  .amdhsa_next_free_vgpr 512
  .amdhsa_next_free_sgpr 102
  .amdhsa_accum_offset 256
  .amdhsa_group_segment_fixed_size 0
  .amdhsa_kernarg_size 96
  .amdhsa_user_sgpr_count 2
  .amdhsa_user_sgpr_kernarg_segment_ptr 1
  .amdhsa_system_sgpr_workgroup_id_x 1
  .amdhsa_float_denorm_mode_32 3
.end_amdhsa_kernel
```
